```python
import torch

def _softmax(x, axis=-1):
    return torch.softmax(x, dim=axis)
def _gelu(x):
    return torch.nn.functional.gelu(x, approximate="tanh")
def _silu(x):
    return torch.nn.functional.silu(x)
def _sigmoid(x):
    return torch.sigmoid(x)
def _layernorm(x, axis=-1, eps=1e-5):
    m = x.mean(dim=axis, keepdim=True)
    v = x.var(dim=axis, keepdim=True, unbiased=False)
    return (x - m) / torch.sqrt(v + eps)
def _scatter_add(tgt, idx, src, axis=0):
    return tgt.clone().index_add_(axis, idx, src)
def _segment_sum(src, seg, n):
    out = torch.zeros((n,) + src.shape[1:], dtype=src.dtype)
    return out.index_add_(0, seg, src)
def _pad(x, pw):
    flat = tuple(v for pair in reversed(pw) for v in pair)
    return torch.nn.functional.pad(x, flat)

kernel_name = 'standalone__structured_sparse_n_m__ragged'

def setup_inputs():

    _w = (lambda a: (lambda t: t.to(torch.bfloat16) if t.is_floating_point() else t)(torch.as_tensor(a)))
    B, S, D = 4, 4096, 512
    assert D % 4 == 0, "d_model must be divisible by M=4 for 2:4 sparsity"
    return {
        "x": _w((lambda *s: torch.randn(*s, dtype=torch.bfloat16) * 0.05)(B, S, D)),
        "w": _w((lambda *s: torch.randn(*s, dtype=torch.bfloat16) * 0.05)(D, D)),
        "b": _w((lambda *s: torch.randn(*s, dtype=torch.bfloat16) * 0.05)(D)),
    }

def reference(x, w, b):
    B, S, D = x.shape
    N, M = 2, 4
    G = D // M
    wg = w.reshape(G, M, D)
    mag = torch.abs(wg)
    order = torch.argsort(mag, 1)
    thr = (lambda x, i, axis: torch.take_along_dim(x, i, dim=axis))(mag, order[:, M - N:M - N + 1, :], 1)
    mask = (lambda x, dt: x.to(dt))(mag >= thr, w.dtype)
    wp = (wg * mask).reshape(D, D)
    return torch.einsum("bsd,df->bsf", x, wp) + b
```

```asm
; @launch grid=(256,1,1) block=(512,1,1) lds=133440
.amdgcn_target "amdgcn-amd-amdhsa--gfx950"
.text
.globl standalone__structured_sparse_n_m__ragged_kernel
.p2align 8
.type standalone__structured_sparse_n_m__ragged_kernel,@function
standalone__structured_sparse_n_m__ragged_kernel:
    s_cmp_ge_u32 s2, 256
    s_cbranch_scc1 L_end
    s_load_dwordx4 s[4:7], s[0:1], 0
    s_load_dwordx4 s[8:11], s[0:1], 16
    s_getpc_b64 s[90:91]
    s_bfe_u32 s92, s2, 0x20003
    s_lshl_b32 s92, s92, 13
    v_lshrrev_b32 v127, 3, v0
    v_lshl_add_u32 v127, v127, 7, s92
    v_min_u32 v127, L_end-standalone__structured_sparse_n_m__ragged_kernel-64, v127
    global_load_dword v127, v127, s[90:91]
    v_and_b32 v1, 63, v0
    v_lshrrev_b32 v2, 6, v0
    s_lshr_b32 s31, s2, 5
    v_readfirstlane_b32 s28, v2
    s_and_b32 s34, s2, 7
    s_lshl_b32 s3, s34, 3
    s_or_b32 s3, s3, s31
    s_lshl_b32 s3, s3, 18
    s_bfe_u32 s32, s2, 0x20003
    s_lshl_b32 s29, s32, 8
    s_mov_b32 s33, 0x100000
    s_cmp_ge_u32 s28, 4
    s_cbranch_scc1 L_cons
    s_mul_i32 s30, s28, 516
    s_add_u32 s30, s30, 131072
    v_lshl_add_u32 v20, v1, 2, s30
    v_mov_b32 v21, 1
    ds_write_b32 v20, v21
    s_lshl_b32 s34, s28, 2
    s_add_u32 s34, s34, 133120
    v_mov_b32 v13, s34
    v_mov_b32 v22, 0
    ds_write_b32 v13, v22
    s_bitcmp1_b32 s32, 0
    s_mov_b32 s93, 0x76543210
    s_cselect_b32 s55, 0x20000, 0
    s_bitcmp1_b32 s32, 1
    s_cselect_b32 s34, 0x8000, 0
    s_or_b32 s55, s55, s34
    s_xor_b32 s34, s2, s31
    s_and_b32 s34, s34, 7
    s_lshl_b32 s34, s34, 15
    s_xor_b32 s55, s55, s34
    s_lshl_b32 s31, s31, 2
    s_add_u32 s31, s31, s2
    s_lshr_b32 s34, s93, 0
    s_add_u32 s34, s34, s31
    s_and_b32 s34, s34, 7
    s_lshl_b32 s44, s34, 7
    s_lshl_b32 s36, s34, 16
    s_lshr_b32 s34, s93, 4
    s_add_u32 s34, s34, s31
    s_and_b32 s34, s34, 7
    s_lshl_b32 s45, s34, 7
    s_lshl_b32 s37, s34, 16
    s_lshl_b32 s89, s28, 12
    s_lshl_b32 s54, s28, 3
    s_lshl_b32 s35, s28, 15
    s_xor_b32 s52, s35, s55
    s_xor_b32 s53, s52, 0x20000
    v_lshrrev_b32 v16, 4, v1
    v_and_b32 v17, 15, v1
    v_lshlrev_b32 v18, 2, v16
    v_xor_b32 v18, v18, v17
    v_lshlrev_b32 v19, 10, v16
    v_lshl_add_u32 v6, v18, 4, v19
    s_lshl_b32 s34, s28, 14
    s_add_u32 s34, s34, s29
    v_add_u32 v6, s34, v6
    v_add_u32 v7, 3072, v6
    v_add_u32 v8, 6144, v6
    v_add_u32 v9, 9216, v6
    v_lshrrev_b32 v18, 3, v1
    v_lshlrev_b32 v18, 10, v18
    v_and_b32 v19, 7, v1
    v_xor_b32 v19, v19, v16
    v_lshl_add_u32 v2, v19, 4, v18
    v_xor_b32 v3, 64, v2
    v_add_u32 v4, 14336, v2
    v_add_u32 v5, 21504, v3
    v_add_u32 v3, 7168, v3
    v_mov_b32 v11, 0x100000
    s_waitcnt lgkmcnt(0)
    s_mov_b32 s16, s6
    s_mov_b32 s17, s7
    s_mov_b32 s18, 0x80000
    s_mov_b32 s19, 0x20000
    s_add_u32 s12, s4, s3
    s_addc_u32 s13, s5, 0
    s_mov_b32 s14, 0x40000
    s_mov_b32 s15, 0x20000
    s_add_u32 m0, s89, 0
    s_nop 0
    buffer_load_dwordx4 v6, s[16:19], s36 offen offset:0 lds
    buffer_load_dwordx4 v7, s[16:19], s36 offen offset:1024 lds
    buffer_load_dwordx4 v8, s[16:19], s36 offen offset:2048 lds
    buffer_load_dwordx4 v9, s[16:19], s36 offen offset:3072 lds
    s_add_u32 m0, s30, 128
    s_nop 0
    buffer_load_dword v11, s[16:19], 0 offen lds
    s_add_u32 m0, s89, 16384
    s_add_u32 s88, s44, s52
    buffer_load_dwordx4 v2, s[12:15], s88 offen offset:0 lds
    buffer_load_dwordx4 v3, s[12:15], s88 offen offset:1024 lds
    buffer_load_dwordx4 v4, s[12:15], s88 offen offset:2048 lds
    buffer_load_dwordx4 v5, s[12:15], s88 offen offset:3072 lds
    s_add_u32 m0, s30, 124
    s_nop 0
    buffer_load_dword v11, s[16:19], 0 offen lds
    s_lshr_b32 s34, s93, 8
    s_add_u32 s34, s34, s31
    s_and_b32 s34, s34, 7
    s_lshl_b32 s46, s34, 7
    s_lshl_b32 s38, s34, 16
    s_lshr_b32 s34, s93, 12
    s_add_u32 s34, s34, s31
    s_and_b32 s34, s34, 7
    s_lshl_b32 s47, s34, 7
    s_lshl_b32 s39, s34, 16
    s_lshr_b32 s34, s93, 16
    s_add_u32 s34, s34, s31
    s_and_b32 s34, s34, 7
    s_lshl_b32 s48, s34, 7
    s_lshl_b32 s40, s34, 16
    s_lshr_b32 s34, s93, 20
    s_add_u32 s34, s34, s31
    s_and_b32 s34, s34, 7
    s_lshl_b32 s49, s34, 7
    s_lshl_b32 s41, s34, 16
    s_lshr_b32 s34, s93, 24
    s_add_u32 s34, s34, s31
    s_and_b32 s34, s34, 7
    s_lshl_b32 s50, s34, 7
    s_lshl_b32 s42, s34, 16
    s_lshr_b32 s34, s93, 28
    s_add_u32 s34, s34, s31
    s_and_b32 s34, s34, 7
    s_lshl_b32 s51, s34, 7
    s_lshl_b32 s43, s34, 16
    v_and_b32 v18, 3, v1
    v_lshlrev_b32 v18, 2, v18
    v_add_u32 v10, 133120, v18
    s_add_u32 m0, s89, 32768
    s_nop 0
    buffer_load_dwordx4 v6, s[16:19], s37 offen offset:0 lds
    buffer_load_dwordx4 v7, s[16:19], s37 offen offset:1024 lds
    buffer_load_dwordx4 v8, s[16:19], s37 offen offset:2048 lds
    buffer_load_dwordx4 v9, s[16:19], s37 offen offset:3072 lds
    buffer_load_dword v12, v11, s[16:19], 0 offen
    s_add_u32 m0, s30, 120
    s_nop 0
    buffer_load_dword v11, s[16:19], 0 offen lds
    s_barrier
    s_waitcnt vmcnt(11)
    s_add_u32 m0, s89, 49152
    s_add_u32 s88, s44, s53
    buffer_load_dwordx4 v2, s[12:15], s88 offen offset:0 lds
    buffer_load_dwordx4 v3, s[12:15], s88 offen offset:1024 lds
    buffer_load_dwordx4 v4, s[12:15], s88 offen offset:2048 lds
    buffer_load_dwordx4 v5, s[12:15], s88 offen offset:3072 lds
    buffer_load_dword v12, v11, s[16:19], 0 offen
    s_waitcnt vmcnt(11)
    s_add_u32 m0, s89, 65536
    s_nop 0
    buffer_load_dwordx4 v6, s[16:19], s38 offen offset:0 lds
    buffer_load_dwordx4 v7, s[16:19], s38 offen offset:1024 lds
    buffer_load_dwordx4 v8, s[16:19], s38 offen offset:2048 lds
    buffer_load_dwordx4 v9, s[16:19], s38 offen offset:3072 lds
    buffer_load_dword v12, v11, s[16:19], 0 offen
    s_add_u32 m0, s30, 116
    s_nop 0
    buffer_load_dword v11, s[16:19], 0 offen lds
    s_waitcnt vmcnt(11)
    s_add_u32 m0, s89, 81920
    s_add_u32 s88, s45, s52
    buffer_load_dwordx4 v2, s[12:15], s88 offen offset:0 lds
    buffer_load_dwordx4 v3, s[12:15], s88 offen offset:1024 lds
    buffer_load_dwordx4 v4, s[12:15], s88 offen offset:2048 lds
    buffer_load_dwordx4 v5, s[12:15], s88 offen offset:3072 lds
    buffer_load_dword v12, v11, s[16:19], 0 offen
    s_waitcnt vmcnt(11)
    s_add_u32 m0, s89, 98304
    s_nop 0
    buffer_load_dwordx4 v6, s[16:19], s39 offen offset:0 lds
    buffer_load_dwordx4 v7, s[16:19], s39 offen offset:1024 lds
    buffer_load_dwordx4 v8, s[16:19], s39 offen offset:2048 lds
    buffer_load_dwordx4 v9, s[16:19], s39 offen offset:3072 lds
    buffer_load_dword v12, v11, s[16:19], 0 offen
    s_add_u32 m0, s30, 112
    s_nop 0
    buffer_load_dword v11, s[16:19], 0 offen lds
    s_waitcnt vmcnt(11)
    s_add_u32 m0, s89, 114688
    s_add_u32 s88, s45, s53
    buffer_load_dwordx4 v2, s[12:15], s88 offen offset:0 lds
    buffer_load_dwordx4 v3, s[12:15], s88 offen offset:1024 lds
    buffer_load_dwordx4 v4, s[12:15], s88 offen offset:2048 lds
    buffer_load_dwordx4 v5, s[12:15], s88 offen offset:3072 lds
    buffer_load_dword v12, v11, s[16:19], 0 offen
    s_waitcnt vmcnt(11)
L_poll_L19:
    ds_read_b32 v14, v10
    s_sub_u32 s33, s33, 1
    s_cbranch_scc1 L_end
    s_waitcnt lgkmcnt(0)
    v_cmp_gt_u32 vcc, 1, v14
    s_cbranch_vccnz L_poll_L19
    s_add_u32 m0, s89, 0
    s_nop 0
    buffer_load_dwordx4 v6, s[16:19], s40 offen offset:0 lds
    buffer_load_dwordx4 v7, s[16:19], s40 offen offset:1024 lds
    buffer_load_dwordx4 v8, s[16:19], s40 offen offset:2048 lds
    buffer_load_dwordx4 v9, s[16:19], s40 offen offset:3072 lds
    buffer_load_dword v12, v11, s[16:19], 0 offen
    s_add_u32 m0, s30, 108
    s_nop 0
    buffer_load_dword v11, s[16:19], 0 offen lds
    s_waitcnt vmcnt(11)
    s_add_u32 m0, s89, 32768
    s_add_u32 s88, s46, s52
    buffer_load_dwordx4 v2, s[12:15], s88 offen offset:0 lds
    buffer_load_dwordx4 v3, s[12:15], s88 offen offset:1024 lds
    buffer_load_dwordx4 v4, s[12:15], s88 offen offset:2048 lds
    buffer_load_dwordx4 v5, s[12:15], s88 offen offset:3072 lds
    buffer_load_dword v12, v11, s[16:19], 0 offen
    s_waitcnt vmcnt(11)
L_poll_L20:
    ds_read_b32 v14, v10
    s_sub_u32 s33, s33, 1
    s_cbranch_scc1 L_end
    s_waitcnt lgkmcnt(0)
    v_cmp_gt_u32 vcc, 2, v14
    s_cbranch_vccnz L_poll_L20
    s_add_u32 m0, s89, 16384
    s_nop 0
    buffer_load_dwordx4 v6, s[16:19], s41 offen offset:0 lds
    buffer_load_dwordx4 v7, s[16:19], s41 offen offset:1024 lds
    buffer_load_dwordx4 v8, s[16:19], s41 offen offset:2048 lds
    buffer_load_dwordx4 v9, s[16:19], s41 offen offset:3072 lds
    buffer_load_dword v12, v11, s[16:19], 0 offen
    s_add_u32 m0, s30, 104
    s_nop 0
    buffer_load_dword v11, s[16:19], 0 offen lds
    s_waitcnt vmcnt(11)
    s_add_u32 m0, s89, 65536
    s_add_u32 s88, s46, s53
    buffer_load_dwordx4 v2, s[12:15], s88 offen offset:0 lds
    buffer_load_dwordx4 v3, s[12:15], s88 offen offset:1024 lds
    buffer_load_dwordx4 v4, s[12:15], s88 offen offset:2048 lds
    buffer_load_dwordx4 v5, s[12:15], s88 offen offset:3072 lds
    buffer_load_dword v12, v11, s[16:19], 0 offen
    s_waitcnt vmcnt(11)
L_poll_L21:
    ds_read_b32 v14, v10
    s_sub_u32 s33, s33, 1
    s_cbranch_scc1 L_end
    s_waitcnt lgkmcnt(0)
    v_cmp_gt_u32 vcc, 3, v14
    s_cbranch_vccnz L_poll_L21
    s_add_u32 m0, s89, 49152
    s_nop 0
    buffer_load_dwordx4 v6, s[16:19], s42 offen offset:0 lds
    buffer_load_dwordx4 v7, s[16:19], s42 offen offset:1024 lds
    buffer_load_dwordx4 v8, s[16:19], s42 offen offset:2048 lds
    buffer_load_dwordx4 v9, s[16:19], s42 offen offset:3072 lds
    buffer_load_dword v12, v11, s[16:19], 0 offen
    s_add_u32 m0, s30, 100
    s_nop 0
    buffer_load_dword v11, s[16:19], 0 offen lds
    s_waitcnt vmcnt(11)
    s_add_u32 m0, s89, 98304
    s_add_u32 s88, s47, s52
    buffer_load_dwordx4 v2, s[12:15], s88 offen offset:0 lds
    buffer_load_dwordx4 v3, s[12:15], s88 offen offset:1024 lds
    buffer_load_dwordx4 v4, s[12:15], s88 offen offset:2048 lds
    buffer_load_dwordx4 v5, s[12:15], s88 offen offset:3072 lds
    buffer_load_dword v12, v11, s[16:19], 0 offen
    s_waitcnt vmcnt(11)
L_poll_L22:
    ds_read_b32 v14, v10
    s_sub_u32 s33, s33, 1
    s_cbranch_scc1 L_end
    s_waitcnt lgkmcnt(0)
    v_cmp_gt_u32 vcc, 4, v14
    s_cbranch_vccnz L_poll_L22
    s_add_u32 m0, s89, 81920
    s_nop 0
    buffer_load_dwordx4 v6, s[16:19], s43 offen offset:0 lds
    buffer_load_dwordx4 v7, s[16:19], s43 offen offset:1024 lds
    buffer_load_dwordx4 v8, s[16:19], s43 offen offset:2048 lds
    buffer_load_dwordx4 v9, s[16:19], s43 offen offset:3072 lds
    buffer_load_dword v12, v11, s[16:19], 0 offen
    s_add_u32 m0, s30, 96
    s_nop 0
    buffer_load_dword v11, s[16:19], 0 offen lds
    s_waitcnt vmcnt(11)
    s_add_u32 m0, s89, 0
    s_add_u32 s88, s47, s53
    buffer_load_dwordx4 v2, s[12:15], s88 offen offset:0 lds
    buffer_load_dwordx4 v3, s[12:15], s88 offen offset:1024 lds
    buffer_load_dwordx4 v4, s[12:15], s88 offen offset:2048 lds
    buffer_load_dwordx4 v5, s[12:15], s88 offen offset:3072 lds
    buffer_load_dword v12, v11, s[16:19], 0 offen
    s_add_u32 m0, s30, 92
    s_nop 0
    buffer_load_dword v11, s[16:19], 0 offen lds
    s_waitcnt vmcnt(12)
L_poll_L23:
    ds_read_b32 v14, v10
    s_sub_u32 s33, s33, 1
    s_cbranch_scc1 L_end
    s_waitcnt lgkmcnt(0)
    v_cmp_gt_u32 vcc, 5, v14
    s_cbranch_vccnz L_poll_L23
    s_add_u32 m0, s89, 114688
    s_lshr_b32 s35, 0x1c181410, s54
    s_lshr_b32 s34, s93, s35
    s_add_u32 s34, s34, s31
    s_and_b32 s34, s34, 7
    s_lshl_b32 s34, s34, 7
    s_bfe_u32 s35, s35, 0x30005
    s_lshl_b32 s35, s35, 15
    s_xor_b32 s35, s35, s55
    s_add_u32 s88, s34, s35
    buffer_load_dwordx4 v2, s[12:15], s88 offen offset:0 lds
    buffer_load_dwordx4 v3, s[12:15], s88 offen offset:1024 lds
    buffer_load_dwordx4 v4, s[12:15], s88 offen offset:2048 lds
    buffer_load_dwordx4 v5, s[12:15], s88 offen offset:3072 lds
    buffer_load_dword v12, v11, s[16:19], 0 offen
    s_add_u32 m0, s30, 88
    s_nop 0
    buffer_load_dword v11, s[16:19], 0 offen lds
    s_waitcnt vmcnt(12)
    s_add_u32 m0, s89, 16384
    s_lshr_b32 s35, 0x3c383430, s54
    s_lshr_b32 s34, s93, s35
    s_add_u32 s34, s34, s31
    s_and_b32 s34, s34, 7
    s_lshl_b32 s34, s34, 7
    s_bfe_u32 s35, s35, 0x30005
    s_lshl_b32 s35, s35, 15
    s_xor_b32 s35, s35, s55
    s_add_u32 s88, s34, s35
    buffer_load_dwordx4 v2, s[12:15], s88 offen offset:0 lds
    buffer_load_dwordx4 v3, s[12:15], s88 offen offset:1024 lds
    buffer_load_dwordx4 v4, s[12:15], s88 offen offset:2048 lds
    buffer_load_dwordx4 v5, s[12:15], s88 offen offset:3072 lds
    buffer_load_dword v12, v11, s[16:19], 0 offen
    s_add_u32 m0, s30, 84
    s_nop 0
    buffer_load_dword v11, s[16:19], 0 offen lds
    s_waitcnt vmcnt(12)
L_poll_L24:
    ds_read_b32 v14, v10
    s_sub_u32 s33, s33, 1
    s_cbranch_scc1 L_end
    s_waitcnt lgkmcnt(0)
    v_cmp_gt_u32 vcc, 6, v14
    s_cbranch_vccnz L_poll_L24
    s_add_u32 m0, s89, 32768
    s_lshr_b32 s35, 0x5c585450, s54
    s_lshr_b32 s34, s93, s35
    s_add_u32 s34, s34, s31
    s_and_b32 s34, s34, 7
    s_lshl_b32 s34, s34, 7
    s_bfe_u32 s35, s35, 0x30005
    s_lshl_b32 s35, s35, 15
    s_xor_b32 s35, s35, s55
    s_add_u32 s88, s34, s35
    buffer_load_dwordx4 v2, s[12:15], s88 offen offset:0 lds
    buffer_load_dwordx4 v3, s[12:15], s88 offen offset:1024 lds
    buffer_load_dwordx4 v4, s[12:15], s88 offen offset:2048 lds
    buffer_load_dwordx4 v5, s[12:15], s88 offen offset:3072 lds
    buffer_load_dword v12, v11, s[16:19], 0 offen
    s_add_u32 m0, s30, 80
    s_nop 0
    buffer_load_dword v11, s[16:19], 0 offen lds
    s_waitcnt vmcnt(12)
    s_add_u32 m0, s89, 49152
    s_lshr_b32 s35, 0x7c787470, s54
    s_lshr_b32 s34, s93, s35
    s_add_u32 s34, s34, s31
    s_and_b32 s34, s34, 7
    s_lshl_b32 s34, s34, 7
    s_bfe_u32 s35, s35, 0x30005
    s_lshl_b32 s35, s35, 15
    s_xor_b32 s35, s35, s55
    s_add_u32 s88, s34, s35
    buffer_load_dwordx4 v2, s[12:15], s88 offen offset:0 lds
    buffer_load_dwordx4 v3, s[12:15], s88 offen offset:1024 lds
    buffer_load_dwordx4 v4, s[12:15], s88 offen offset:2048 lds
    buffer_load_dwordx4 v5, s[12:15], s88 offen offset:3072 lds
    buffer_load_dword v12, v11, s[16:19], 0 offen
    s_add_u32 m0, s30, 76
    s_nop 0
    buffer_load_dword v11, s[16:19], 0 offen lds
    s_waitcnt vmcnt(12)
L_poll_L25:
    ds_read_b32 v14, v10
    s_sub_u32 s33, s33, 1
    s_cbranch_scc1 L_end
    s_waitcnt lgkmcnt(0)
    v_cmp_gt_u32 vcc, 7, v14
    s_cbranch_vccnz L_poll_L25
    s_add_u32 m0, s89, 65536
    s_lshr_b32 s35, 0x9c989490, s54
    s_lshr_b32 s34, s93, s35
    s_add_u32 s34, s34, s31
    s_and_b32 s34, s34, 7
    s_lshl_b32 s34, s34, 7
    s_bfe_u32 s35, s35, 0x30005
    s_lshl_b32 s35, s35, 15
    s_xor_b32 s35, s35, s55
    s_add_u32 s88, s34, s35
    buffer_load_dwordx4 v2, s[12:15], s88 offen offset:0 lds
    buffer_load_dwordx4 v3, s[12:15], s88 offen offset:1024 lds
    buffer_load_dwordx4 v4, s[12:15], s88 offen offset:2048 lds
    buffer_load_dwordx4 v5, s[12:15], s88 offen offset:3072 lds
    buffer_load_dword v12, v11, s[16:19], 0 offen
    s_add_u32 m0, s30, 72
    s_nop 0
    buffer_load_dword v11, s[16:19], 0 offen lds
    s_waitcnt vmcnt(12)
    s_add_u32 m0, s89, 81920
    s_lshr_b32 s35, 0xbcb8b4b0, s54
    s_lshr_b32 s34, s93, s35
    s_add_u32 s34, s34, s31
    s_and_b32 s34, s34, 7
    s_lshl_b32 s34, s34, 7
    s_bfe_u32 s35, s35, 0x30005
    s_lshl_b32 s35, s35, 15
    s_xor_b32 s35, s35, s55
    s_add_u32 s88, s34, s35
    buffer_load_dwordx4 v2, s[12:15], s88 offen offset:0 lds
    buffer_load_dwordx4 v3, s[12:15], s88 offen offset:1024 lds
    buffer_load_dwordx4 v4, s[12:15], s88 offen offset:2048 lds
    buffer_load_dwordx4 v5, s[12:15], s88 offen offset:3072 lds
    buffer_load_dword v12, v11, s[16:19], 0 offen
    s_add_u32 m0, s30, 68
    s_nop 0
    buffer_load_dword v11, s[16:19], 0 offen lds
    s_waitcnt vmcnt(12)
L_poll_L26:
    ds_read_b32 v14, v10
    s_sub_u32 s33, s33, 1
    s_cbranch_scc1 L_end
    s_waitcnt lgkmcnt(0)
    v_cmp_gt_u32 vcc, 8, v14
    s_cbranch_vccnz L_poll_L26
    s_add_u32 m0, s89, 98304
    s_lshr_b32 s35, 0xdcd8d4d0, s54
    s_lshr_b32 s34, s93, s35
    s_add_u32 s34, s34, s31
    s_and_b32 s34, s34, 7
    s_lshl_b32 s34, s34, 7
    s_bfe_u32 s35, s35, 0x30005
    s_lshl_b32 s35, s35, 15
    s_xor_b32 s35, s35, s55
    s_add_u32 s88, s34, s35
    buffer_load_dwordx4 v2, s[12:15], s88 offen offset:0 lds
    buffer_load_dwordx4 v3, s[12:15], s88 offen offset:1024 lds
    buffer_load_dwordx4 v4, s[12:15], s88 offen offset:2048 lds
    buffer_load_dwordx4 v5, s[12:15], s88 offen offset:3072 lds
    buffer_load_dword v12, v11, s[16:19], 0 offen
    s_add_u32 m0, s30, 64
    s_nop 0
    buffer_load_dword v11, s[16:19], 0 offen lds
    s_waitcnt vmcnt(12)
L_poll_L27:
    ds_read_b32 v14, v10
    s_sub_u32 s33, s33, 1
    s_cbranch_scc1 L_end
    s_waitcnt lgkmcnt(0)
    v_cmp_gt_u32 vcc, 9, v14
    s_cbranch_vccnz L_poll_L27
    s_add_u32 m0, s89, 0
    s_lshr_b32 s35, 0xfcf8f4f0, s54
    s_lshr_b32 s34, s93, s35
    s_add_u32 s34, s34, s31
    s_and_b32 s34, s34, 7
    s_lshl_b32 s34, s34, 7
    s_bfe_u32 s35, s35, 0x30005
    s_lshl_b32 s35, s35, 15
    s_xor_b32 s35, s35, s55
    s_add_u32 s88, s34, s35
    buffer_load_dwordx4 v2, s[12:15], s88 offen offset:0 lds
    buffer_load_dwordx4 v3, s[12:15], s88 offen offset:1024 lds
    buffer_load_dwordx4 v4, s[12:15], s88 offen offset:2048 lds
    buffer_load_dwordx4 v5, s[12:15], s88 offen offset:3072 lds
    buffer_load_dword v12, v11, s[16:19], 0 offen
    s_add_u32 m0, s30, 60
    s_nop 0
    buffer_load_dword v11, s[16:19], 0 offen lds
    s_waitcnt vmcnt(12)
    s_waitcnt vmcnt(0)
    s_endpgm
.p2align 3
L_cons:
    s_sub_u32 s36, s28, 4
    v_lshrrev_b32 v18, 4, v1
    v_and_b32 v16, 15, v1
    v_bfe_u32 v17, v1, 1, 3
    v_xor_b32 v17, v17, v18
    v_lshlrev_b32 v19, 7, v16
    v_lshl_add_u32 v2, v17, 4, v19
    v_xor_b32 v3, 64, v2
    v_add_u32 v4, 0x10000, v2
    v_add_u32 v5, 0x10000, v3
    s_waitcnt lgkmcnt(0)
    s_lshl_b32 s34, s36, 6
    s_add_u32 s34, s34, s29
    s_add_u32 s12, s8, s34
    s_addc_u32 s13, s9, 0
    s_load_dwordx16 s[40:55], s[12:13], 0
    s_mov_b32 s37, s34
    s_add_u32 s20, s10, s3
    s_addc_u32 s21, s11, 0
    s_mov_b32 s22, 0x40000
    s_mov_b32 s23, 0x20000
    s_bitcmp1_b32 s32, 0
    s_cselect_b32 s38, 0x20000, 0
    s_bitcmp1_b32 s32, 1
    s_cselect_b32 s39, 0x8000, 0
    s_or_b32 s38, s38, s39
    s_xor_b32 s34, s2, s31
    s_and_b32 s34, s34, 7
    s_lshl_b32 s34, s34, 15
    s_xor_b32 s38, s38, s34
    s_barrier
    v_bfe_u32 v16, v1, 2, 2
    v_lshl_add_u32 v17, v18, 3, v16
    v_lshlrev_b32 v6, 8, v17
    v_xor_b32 v16, s36, v16
    v_lshl_add_u32 v6, v16, 6, v6
    v_and_b32 v16, 3, v1
    v_lshl_add_u32 v6, v16, 4, v6
    v_add_u32 v7, 0x10000, v6
    v_and_b32 v8, 3, v1
    v_mul_u32_u24 v8, 516, v8
    v_add_u32 v8, 131072, v8
    s_lshl_b32 s35, s36, 2
    s_add_u32 s35, s35, 133120
    v_mov_b32 v9, s35
    v_mov_b32 v12, 0x80008000
    s_waitcnt vmcnt(0)
    v_mov_b32 v16, 0xffff0000
    s_waitcnt lgkmcnt(0)
    v_lshlrev_b32_e64 v96, 16, s40
    v_and_b32 v97, s40, v16
    v_lshlrev_b32_e64 v98, 16, s41
    v_and_b32 v99, s41, v16
    v_lshlrev_b32_e64 v100, 16, s42
    v_and_b32 v101, s42, v16
    v_lshlrev_b32_e64 v102, 16, s43
    v_and_b32 v103, s43, v16
    s_mov_b32 exec_lo, 0xffff0000
    v_lshlrev_b32_e64 v96, 16, s44
    v_and_b32 v97, s44, v16
    v_lshlrev_b32_e64 v98, 16, s45
    v_and_b32 v99, s45, v16
    v_lshlrev_b32_e64 v100, 16, s46
    v_and_b32 v101, s46, v16
    v_lshlrev_b32_e64 v102, 16, s47
    v_and_b32 v103, s47, v16
    s_mov_b32 exec_lo, 0
    v_lshlrev_b32_e64 v96, 16, s48
    v_and_b32 v97, s48, v16
    v_lshlrev_b32_e64 v98, 16, s49
    v_and_b32 v99, s49, v16
    v_lshlrev_b32_e64 v100, 16, s50
    v_and_b32 v101, s50, v16
    v_lshlrev_b32_e64 v102, 16, s51
    v_and_b32 v103, s51, v16
    s_mov_b32 exec_hi, 0xffff0000
    v_lshlrev_b32_e64 v96, 16, s52
    v_and_b32 v97, s52, v16
    v_lshlrev_b32_e64 v98, 16, s53
    v_and_b32 v99, s53, v16
    v_lshlrev_b32_e64 v100, 16, s54
    v_and_b32 v101, s54, v16
    v_lshlrev_b32_e64 v102, 16, s55
    v_and_b32 v103, s55, v16
    s_mov_b64 exec, -1
    s_setprio 3
L_poll_C1:
    ds_read_b32 v11, v8 offset:128
    s_sub_u32 s33, s33, 1
    s_cbranch_scc1 L_end
    s_waitcnt lgkmcnt(0)
    v_cmp_ne_u32 vcc, 0, v11
    s_cbranch_vccnz L_poll_C1
    ds_read_b64_tr_b16 v[48:49], v6 offset:0
    ds_read_b64_tr_b16 v[50:51], v6 offset:1024
    ds_read_b64_tr_b16 v[52:53], v6 offset:8
    ds_read_b64_tr_b16 v[54:55], v6 offset:1032
    ds_read_b64_tr_b16 v[56:57], v6 offset:8192
    ds_read_b64_tr_b16 v[58:59], v6 offset:9216
    ds_read_b64_tr_b16 v[60:61], v6 offset:8200
    ds_read_b64_tr_b16 v[62:63], v6 offset:9224
    s_waitcnt lgkmcnt(6)
    v_or_b32 v44, v12, v48
    v_or_b32_e64 v45, v12, v49
    v_pk_max_u16 v46, v44, v45
    v_pk_min_u16 v47, v44, v45
    v_pk_min_u16 v46, v46, v46 op_sel:[0,1] op_sel_hi:[1,0]
    v_pk_max_u16 v46, v46, v47
    v_pk_max_u16 v46, v46, v46 op_sel:[0,1] op_sel_hi:[1,0]
    v_pk_sub_i16 v44, v44, v46
    v_pk_sub_i16 v45, v45, v46
    v_pk_ashrrev_i16 v44, 15, v44 op_sel_hi:[0,1]
    v_pk_ashrrev_i16 v45, 15, v45 op_sel_hi:[0,1]
    v_bfi_b32 v48, v44, 0, v48
    v_bfi_b32 v49, v45, 0, v49
    v_or_b32 v44, v12, v50
    v_or_b32 v45, v12, v51
    v_pk_max_u16 v46, v44, v45
    v_pk_min_u16 v47, v44, v45
    v_pk_min_u16 v46, v46, v46 op_sel:[0,1] op_sel_hi:[1,0]
    v_pk_max_u16 v46, v46, v47
    v_pk_max_u16 v46, v46, v46 op_sel:[0,1] op_sel_hi:[1,0]
    v_pk_sub_i16 v44, v44, v46
    v_pk_sub_i16 v45, v45, v46
    v_pk_ashrrev_i16 v44, 15, v44 op_sel_hi:[0,1]
    v_pk_ashrrev_i16 v45, 15, v45 op_sel_hi:[0,1]
    v_bfi_b32 v50, v44, 0, v50
    v_bfi_b32 v51, v45, 0, v51
    s_waitcnt lgkmcnt(4)
    v_or_b32 v44, v12, v52
    v_or_b32_e64 v45, v12, v53
    v_pk_max_u16 v46, v44, v45
    v_pk_min_u16 v47, v44, v45
    v_pk_min_u16 v46, v46, v46 op_sel:[0,1] op_sel_hi:[1,0]
    v_pk_max_u16 v46, v46, v47
    v_pk_max_u16 v46, v46, v46 op_sel:[0,1] op_sel_hi:[1,0]
    v_pk_sub_i16 v44, v44, v46
    v_pk_sub_i16 v45, v45, v46
    v_pk_ashrrev_i16 v44, 15, v44 op_sel_hi:[0,1]
    v_pk_ashrrev_i16 v45, 15, v45 op_sel_hi:[0,1]
    v_bfi_b32 v52, v44, 0, v52
    v_bfi_b32 v53, v45, 0, v53
    v_or_b32 v44, v12, v54
    v_or_b32 v45, v12, v55
    v_pk_max_u16 v46, v44, v45
    v_pk_min_u16 v47, v44, v45
    v_pk_min_u16 v46, v46, v46 op_sel:[0,1] op_sel_hi:[1,0]
    v_pk_max_u16 v46, v46, v47
    v_pk_max_u16 v46, v46, v46 op_sel:[0,1] op_sel_hi:[1,0]
    v_pk_sub_i16 v44, v44, v46
    v_pk_sub_i16 v45, v45, v46
    v_pk_ashrrev_i16 v44, 15, v44 op_sel_hi:[0,1]
    v_pk_ashrrev_i16 v45, 15, v45 op_sel_hi:[0,1]
    v_bfi_b32 v54, v44, 0, v54
    v_bfi_b32 v55, v45, 0, v55
L_poll_C2:
    ds_read_b32 v11, v8 offset:124
    s_sub_u32 s33, s33, 1
    s_cbranch_scc1 L_end
    s_waitcnt lgkmcnt(0)
    v_cmp_ne_u32 vcc, 0, v11
    s_cbranch_vccnz L_poll_C2
    s_nop 0
    ds_read_b128 v[16:19], v2 offset:16384
    ds_read_b128 v[20:23], v2 offset:18432
    ds_read_b128 v[24:27], v2 offset:20480
    ds_read_b128 v[28:31], v2 offset:22528
    ds_read_b128 v[32:35], v2 offset:24576
    ds_read_b128 v[36:39], v2 offset:26624
    s_waitcnt lgkmcnt(5)
    v_mfma_f32_16x16x32_bf16 v[128:131], v[48:51], v[16:19], v[96:99]
    ds_read_b128 v[40:43], v2 offset:28672
    ds_read_b32 v11, v8 offset:120
    v_or_b32 v44, v12, v56
    v_or_b32_e64 v45, v12, v57
    v_pk_max_u16 v46, v44, v45
    v_mfma_f32_16x16x32_bf16 v[132:135], v[52:55], v[16:19], v[100:103]
    v_pk_min_u16 v47, v44, v45
    v_pk_min_u16 v46, v46, v46 op_sel:[0,1] op_sel_hi:[1,0]
    v_pk_max_u16 v46, v46, v47
    v_pk_max_u16 v46, v46, v46 op_sel:[0,1] op_sel_hi:[1,0]
    v_pk_sub_i16 v44, v44, v46
    s_waitcnt lgkmcnt(6)
    v_mfma_f32_16x16x32_bf16 v[136:139], v[48:51], v[20:23], v[96:99]
    ds_read_b128 v[16:19], v2 offset:30720
    s_waitcnt lgkmcnt(1)
    v_cmp_ne_u32 vcc, 0, v11
    s_cbranch_vccnz L_spin_C3
L_back_C3:
    v_pk_sub_i16 v45, v45, v46
    v_pk_ashrrev_i16 v44, 15, v44 op_sel_hi:[0,1]
    v_mfma_f32_16x16x32_bf16 v[140:143], v[52:55], v[20:23], v[100:103]
    v_pk_ashrrev_i16 v45, 15, v45 op_sel_hi:[0,1]
    v_bfi_b32 v56, v44, 0, v56
    v_bfi_b32 v57, v45, 0, v57
    v_or_b32 v44, v12, v58
    v_or_b32 v45, v12, v59
    v_pk_max_u16 v46, v44, v45
    v_mfma_f32_16x16x32_bf16 v[144:147], v[48:51], v[24:27], v[96:99]
    ds_read_b128 v[20:23], v3 offset:16384
    ds_read_b64_tr_b16 v[64:65], v6 offset:32768
    ds_read_b64_tr_b16 v[66:67], v6 offset:33792
    v_pk_min_u16 v47, v44, v45
    v_pk_min_u16 v46, v46, v46 op_sel:[0,1] op_sel_hi:[1,0]
    v_pk_max_u16 v46, v46, v47
    v_mfma_f32_16x16x32_bf16 v[148:151], v[52:55], v[24:27], v[100:103]
    v_pk_max_u16 v46, v46, v46 op_sel:[0,1] op_sel_hi:[1,0]
    v_pk_sub_i16 v44, v44, v46
    v_pk_sub_i16 v45, v45, v46
    v_pk_ashrrev_i16 v44, 15, v44 op_sel_hi:[0,1]
    v_pk_ashrrev_i16 v45, 15, v45 op_sel_hi:[0,1]
    v_mfma_f32_16x16x32_bf16 v[152:155], v[48:51], v[28:31], v[96:99]
    ds_read_b128 v[24:27], v3 offset:18432
    ds_read_b64_tr_b16 v[68:69], v6 offset:32776
    ds_read_b64_tr_b16 v[70:71], v6 offset:33800
    v_bfi_b32 v58, v44, 0, v58
    v_bfi_b32 v59, v45, 0, v59
    v_or_b32_e64 v44, v12, v60
    v_mfma_f32_16x16x32_bf16 v[156:159], v[52:55], v[28:31], v[100:103]
    v_or_b32_e64 v45, v12, v61
    v_pk_max_u16 v46, v44, v45
    v_pk_min_u16 v47, v44, v45
    v_pk_min_u16 v46, v46, v46 op_sel:[0,1] op_sel_hi:[1,0]
    v_pk_max_u16 v46, v46, v47
    v_mfma_f32_16x16x32_bf16 v[160:163], v[48:51], v[32:35], v[96:99]
    ds_read_b128 v[28:31], v3 offset:20480
    ds_read_b64_tr_b16 v[72:73], v6 offset:40960
    ds_read_b64_tr_b16 v[74:75], v6 offset:41984
    v_pk_max_u16 v46, v46, v46 op_sel:[0,1] op_sel_hi:[1,0]
    v_pk_sub_i16 v44, v44, v46
    v_mfma_f32_16x16x32_bf16 v[164:167], v[52:55], v[32:35], v[100:103]
    v_pk_sub_i16 v45, v45, v46
    v_pk_ashrrev_i16 v44, 15, v44 op_sel_hi:[0,1]
    v_pk_ashrrev_i16 v45, 15, v45 op_sel_hi:[0,1]
    v_bfi_b32 v60, v44, 0, v60
    v_bfi_b32 v61, v45, 0, v61
    v_mfma_f32_16x16x32_bf16 v[168:171], v[48:51], v[36:39], v[96:99]
    s_waitcnt lgkmcnt(8)
    ds_read_b128 v[32:35], v3 offset:22528
    ds_read_b64_tr_b16 v[76:77], v6 offset:40968
    ds_read_b64_tr_b16 v[78:79], v6 offset:41992
    v_or_b32 v44, v12, v62
    v_or_b32_e64 v45, v12, v63
    v_mfma_f32_16x16x32_bf16 v[172:175], v[52:55], v[36:39], v[100:103]
    v_pk_max_u16 v46, v44, v45
    v_pk_min_u16 v47, v44, v45
    v_pk_min_u16 v46, v46, v46 op_sel:[0,1] op_sel_hi:[1,0]
    v_pk_max_u16 v46, v46, v47
    v_pk_max_u16 v46, v46, v46 op_sel:[0,1] op_sel_hi:[1,0]
    v_mfma_f32_16x16x32_bf16 v[176:179], v[48:51], v[40:43], v[96:99]
    ds_read_b128 v[36:39], v3 offset:24576
    v_mov_b32_e64 v10, 1
    ds_write_b32 v9, v10
    v_pk_sub_i16 v44, v44, v46
    v_pk_sub_i16 v45, v45, v46
    v_mfma_f32_16x16x32_bf16 v[180:183], v[52:55], v[40:43], v[100:103]
    v_pk_ashrrev_i16 v44, 15, v44 op_sel_hi:[0,1]
    v_pk_ashrrev_i16 v45, 15, v45 op_sel_hi:[0,1]
    v_bfi_b32 v62, v44, 0, v62
    v_bfi_b32 v63, v45, 0, v63
    s_waitcnt lgkmcnt(11)
    v_mfma_f32_16x16x32_bf16 v[184:187], v[48:51], v[16:19], v[96:99]
    ds_read_b32 v11, v8 offset:116
    ds_read_b128 v[40:43], v3 offset:26624
    v_or_b32 v44, v12, v64
    v_or_b32_e64 v45, v12, v65
    v_pk_max_u16 v46, v44, v45
    v_mfma_f32_16x16x32_bf16 v[188:191], v[52:55], v[16:19], v[100:103]
    v_pk_min_u16 v47, v44, v45
    v_pk_min_u16 v46, v46, v46 op_sel:[0,1] op_sel_hi:[1,0]
    v_pk_max_u16 v46, v46, v47
    v_pk_max_u16 v46, v46, v46 op_sel:[0,1] op_sel_hi:[1,0]
    v_mfma_f32_16x16x32_bf16 v[128:131], v[56:59], v[20:23], v[128:131]
    s_waitcnt lgkmcnt(6)
    s_nop 0
    ds_read_b128 v[16:19], v3 offset:28672
    v_pk_sub_i16 v44, v44, v46
    v_pk_sub_i16 v45, v45, v46
    v_pk_ashrrev_i16 v44, 15, v44 op_sel_hi:[0,1]
    v_mfma_f32_16x16x32_bf16 v[132:135], v[60:63], v[20:23], v[132:135]
    v_pk_ashrrev_i16 v45, 15, v45 op_sel_hi:[0,1]
    v_bfi_b32 v64, v44, 0, v64
    v_bfi_b32 v65, v45, 0, v65
    v_or_b32_e64 v44, v12, v66
    v_mfma_f32_16x16x32_bf16 v[136:139], v[56:59], v[24:27], v[136:139]
    ds_read_b128 v[20:23], v3 offset:30720
    v_or_b32_e64 v45, v12, v67
    v_pk_max_u16 v46, v44, v45
    v_pk_min_u16 v47, v44, v45
    v_pk_min_u16 v46, v46, v46 op_sel:[0,1] op_sel_hi:[1,0]
    v_mfma_f32_16x16x32_bf16 v[140:143], v[60:63], v[24:27], v[140:143]
    v_pk_max_u16 v46, v46, v47
    v_pk_max_u16 v46, v46, v46 op_sel:[0,1] op_sel_hi:[1,0]
    v_pk_sub_i16 v44, v44, v46
    s_waitcnt lgkmcnt(3)
    v_cmp_ne_u32 vcc, 0, v11
    v_mfma_f32_16x16x32_bf16 v[144:147], v[56:59], v[28:31], v[144:147]
    s_cbranch_vccnz L_spin_C4
L_back_C4:
    s_nop 0
    ds_read_b128 v[24:27], v2 offset:49152
    ds_read_b64_tr_b16 v[80:81], v7 offset:0
    ds_read_b64_tr_b16 v[82:83], v7 offset:1024
    v_pk_sub_i16 v45, v45, v46
    v_mfma_f32_16x16x32_bf16 v[148:151], v[60:63], v[28:31], v[148:151]
    v_pk_ashrrev_i16 v44, 15, v44 op_sel_hi:[0,1]
    v_pk_ashrrev_i16 v45, 15, v45 op_sel_hi:[0,1]
    v_bfi_b32 v66, v44, 0, v66
    v_bfi_b32 v67, v45, 0, v67
    v_or_b32 v44, v12, v68
    v_or_b32 v45, v12, v69
    v_mfma_f32_16x16x32_bf16 v[152:155], v[56:59], v[32:35], v[152:155]
    s_waitcnt lgkmcnt(4)
    s_nop 0
    ds_read_b128 v[28:31], v2 offset:51200
    ds_read_b64_tr_b16 v[84:85], v7 offset:8
    ds_read_b64_tr_b16 v[86:87], v7 offset:1032
    v_pk_max_u16 v46, v44, v45
    v_pk_min_u16 v47, v44, v45
    v_mfma_f32_16x16x32_bf16 v[156:159], v[60:63], v[32:35], v[156:159]
    v_pk_min_u16 v46, v46, v46 op_sel:[0,1] op_sel_hi:[1,0]
    v_pk_max_u16 v46, v46, v47
    v_pk_max_u16 v46, v46, v46 op_sel:[0,1] op_sel_hi:[1,0]
    v_pk_sub_i16 v44, v44, v46
    v_pk_sub_i16 v45, v45, v46
    v_mfma_f32_16x16x32_bf16 v[160:163], v[56:59], v[36:39], v[160:163]
    ds_read_b128 v[32:35], v2 offset:53248
    ds_read_b64_tr_b16 v[88:89], v7 offset:8192
    ds_read_b64_tr_b16 v[90:91], v7 offset:9216
    v_pk_ashrrev_i16 v44, 15, v44 op_sel_hi:[0,1]
    v_pk_ashrrev_i16 v45, 15, v45 op_sel_hi:[0,1]
    v_mfma_f32_16x16x32_bf16 v[164:167], v[60:63], v[36:39], v[164:167]
    v_bfi_b32 v68, v44, 0, v68
    v_bfi_b32 v69, v45, 0, v69
    v_or_b32 v44, v12, v70
    v_or_b32 v45, v12, v71
    v_pk_max_u16 v46, v44, v45
    v_mfma_f32_16x16x32_bf16 v[168:171], v[56:59], v[40:43], v[168:171]
    ds_read_b128 v[36:39], v2 offset:55296
    ds_read_b64_tr_b16 v[92:93], v7 offset:8200
    ds_read_b64_tr_b16 v[94:95], v7 offset:9224
    v_pk_min_u16 v47, v44, v45
    v_pk_min_u16 v46, v46, v46 op_sel:[0,1] op_sel_hi:[1,0]
    v_mfma_f32_16x16x32_bf16 v[172:175], v[60:63], v[40:43], v[172:175]
    v_pk_max_u16 v46, v46, v47
    v_pk_max_u16 v46, v46, v46 op_sel:[0,1] op_sel_hi:[1,0]
    v_pk_sub_i16 v44, v44, v46
    v_pk_sub_i16 v45, v45, v46
    v_pk_ashrrev_i16 v44, 15, v44 op_sel_hi:[0,1]
    v_mfma_f32_16x16x32_bf16 v[176:179], v[56:59], v[16:19], v[176:179]
    s_waitcnt lgkmcnt(8)
    ds_read_b128 v[40:43], v2 offset:57344
    v_mov_b32 v10, 2
    ds_write_b32 v9, v10
    v_pk_ashrrev_i16 v45, 15, v45 op_sel_hi:[0,1]
    v_bfi_b32 v70, v44, 0, v70
    v_mfma_f32_16x16x32_bf16 v[180:183], v[60:63], v[16:19], v[180:183]
    v_bfi_b32 v71, v45, 0, v71
    v_or_b32 v44, v12, v72
    v_or_b32 v45, v12, v73
    v_pk_max_u16 v46, v44, v45
    v_pk_min_u16 v47, v44, v45
    v_mfma_f32_16x16x32_bf16 v[184:187], v[56:59], v[20:23], v[184:187]
    ds_read_b128 v[16:19], v2 offset:59392
    v_pk_min_u16 v46, v46, v46 op_sel:[0,1] op_sel_hi:[1,0]
    v_pk_max_u16 v46, v46, v47
    v_pk_max_u16 v46, v46, v46 op_sel:[0,1] op_sel_hi:[1,0]
    v_mfma_f32_16x16x32_bf16 v[188:191], v[60:63], v[20:23], v[188:191]
    v_pk_sub_i16 v44, v44, v46
    v_pk_sub_i16 v45, v45, v46
    v_pk_ashrrev_i16 v44, 15, v44 op_sel_hi:[0,1]
    v_pk_ashrrev_i16 v45, 15, v45 op_sel_hi:[0,1]
    v_mfma_f32_16x16x32_bf16 v[192:195], v[48:51], v[24:27], v[96:99]
    ds_read_b128 v[20:23], v2 offset:61440
    v_bfi_b32 v72, v44, 0, v72
    v_bfi_b32 v73, v45, 0, v73
    v_or_b32_e64 v44, v12, v74
    v_mfma_f32_16x16x32_bf16 v[196:199], v[52:55], v[24:27], v[100:103]
    v_or_b32_e64 v45, v12, v75
    v_pk_max_u16 v46, v44, v45
    v_pk_min_u16 v47, v44, v45
    v_pk_min_u16 v46, v46, v46 op_sel:[0,1] op_sel_hi:[1,0]
    v_mfma_f32_16x16x32_bf16 v[200:203], v[48:51], v[28:31], v[96:99]
    s_waitcnt lgkmcnt(3)
    s_nop 0
    ds_read_b128 v[24:27], v2 offset:63488
    v_pk_max_u16 v46, v46, v47
    v_pk_max_u16 v46, v46, v46 op_sel:[0,1] op_sel_hi:[1,0]
    v_pk_sub_i16 v44, v44, v46
    v_mfma_f32_16x16x32_bf16 v[204:207], v[52:55], v[28:31], v[100:103]
    v_pk_sub_i16 v45, v45, v46
    v_pk_ashrrev_i16 v44, 15, v44 op_sel_hi:[0,1]
    v_pk_ashrrev_i16 v45, 15, v45 op_sel_hi:[0,1]
    v_bfi_b32 v74, v44, 0, v74
    v_mfma_f32_16x16x32_bf16 v[208:211], v[48:51], v[32:35], v[96:99]
    ds_read_b128 v[28:31], v3 offset:49152
    v_bfi_b32 v75, v45, 0, v75
    v_or_b32 v44, v12, v76
    v_or_b32 v45, v12, v77
    v_mfma_f32_16x16x32_bf16 v[212:215], v[52:55], v[32:35], v[100:103]
    v_pk_max_u16 v46, v44, v45
    v_pk_min_u16 v47, v44, v45
    v_pk_min_u16 v46, v46, v46 op_sel:[0,1] op_sel_hi:[1,0]
    v_pk_max_u16 v46, v46, v47
    v_mfma_f32_16x16x32_bf16 v[216:219], v[48:51], v[36:39], v[96:99]
    ds_read_b128 v[32:35], v3 offset:51200
    v_pk_max_u16 v46, v46, v46 op_sel:[0,1] op_sel_hi:[1,0]
    v_pk_sub_i16 v44, v44, v46
    v_pk_sub_i16 v45, v45, v46
    v_mfma_f32_16x16x32_bf16 v[220:223], v[52:55], v[36:39], v[100:103]
    v_pk_ashrrev_i16 v44, 15, v44 op_sel_hi:[0,1]
    v_pk_ashrrev_i16 v45, 15, v45 op_sel_hi:[0,1]
    v_bfi_b32 v76, v44, 0, v76
    v_bfi_b32 v77, v45, 0, v77
    v_mfma_f32_16x16x32_bf16 v[224:227], v[48:51], v[40:43], v[96:99]
    s_waitcnt lgkmcnt(2)
    ds_read_b128 v[36:39], v3 offset:53248
    v_or_b32 v44, v12, v78
    v_or_b32_e64 v45, v12, v79
    v_pk_max_u16 v46, v44, v45
    v_mfma_f32_16x16x32_bf16 v[228:231], v[52:55], v[40:43], v[100:103]
    v_pk_min_u16 v47, v44, v45
    v_pk_min_u16 v46, v46, v46 op_sel:[0,1] op_sel_hi:[1,0]
    v_pk_max_u16 v46, v46, v47
    v_pk_max_u16 v46, v46, v46 op_sel:[0,1] op_sel_hi:[1,0]
    v_mfma_f32_16x16x32_bf16 v[232:235], v[48:51], v[16:19], v[96:99]
    ds_read_b128 v[40:43], v3 offset:55296
    v_pk_sub_i16 v44, v44, v46
    v_pk_sub_i16 v45, v45, v46
    v_pk_ashrrev_i16 v44, 15, v44 op_sel_hi:[0,1]
    v_mfma_f32_16x16x32_bf16 v[236:239], v[52:55], v[16:19], v[100:103]
    v_pk_ashrrev_i16 v45, 15, v45 op_sel_hi:[0,1]
    v_bfi_b32 v78, v44, 0, v78
    v_bfi_b32 v79, v45, 0, v79
    v_or_b32_e64 v44, v12, v80
    v_mfma_f32_16x16x32_bf16 v[240:243], v[48:51], v[20:23], v[96:99]
    ds_read_b128 v[16:19], v3 offset:57344
    v_or_b32_e64 v45, v12, v81
    v_pk_max_u16 v46, v44, v45
    v_pk_min_u16 v47, v44, v45
    v_mfma_f32_16x16x32_bf16 v[244:247], v[52:55], v[20:23], v[100:103]
    v_pk_min_u16 v46, v46, v46 op_sel:[0,1] op_sel_hi:[1,0]
    v_pk_max_u16 v46, v46, v47
    v_pk_max_u16 v46, v46, v46 op_sel:[0,1] op_sel_hi:[1,0]
    v_pk_sub_i16 v44, v44, v46
    v_mfma_f32_16x16x32_bf16 v[248:251], v[48:51], v[24:27], v[96:99]
    s_waitcnt lgkmcnt(2)
    s_nop 0
    ds_read_b32 v11, v8 offset:112
    ds_read_b128 v[20:23], v3 offset:59392
    v_pk_sub_i16 v45, v45, v46
    v_pk_ashrrev_i16 v44, 15, v44 op_sel_hi:[0,1]
    v_mfma_f32_16x16x32_bf16 v[252:255], v[52:55], v[24:27], v[100:103]
    v_pk_ashrrev_i16 v45, 15, v45 op_sel_hi:[0,1]
    v_bfi_b32 v80, v44, 0, v80
    v_bfi_b32 v81, v45, 0, v81
    v_or_b32 v44, v12, v82
    v_or_b32 v45, v12, v83
    v_mfma_f32_16x16x32_bf16 v[192:195], v[56:59], v[28:31], v[192:195]
    ds_read_b128 v[24:27], v3 offset:61440
    v_pk_max_u16 v46, v44, v45
    v_pk_min_u16 v47, v44, v45
    v_pk_min_u16 v46, v46, v46 op_sel:[0,1] op_sel_hi:[1,0]
    v_mfma_f32_16x16x32_bf16 v[196:199], v[60:63], v[28:31], v[196:199]
    v_pk_max_u16 v46, v46, v47
    v_pk_max_u16 v46, v46, v46 op_sel:[0,1] op_sel_hi:[1,0]
    v_pk_sub_i16 v44, v44, v46
    v_pk_sub_i16 v45, v45, v46
    v_mfma_f32_16x16x32_bf16 v[200:203], v[56:59], v[32:35], v[200:203]
    ds_read_b128 v[28:31], v3 offset:63488
    v_pk_ashrrev_i16 v44, 15, v44 op_sel_hi:[0,1]
    v_pk_ashrrev_i16 v45, 15, v45 op_sel_hi:[0,1]
    v_bfi_b32 v82, v44, 0, v82
    v_bfi_b32 v83, v45, 0, v83
    v_mfma_f32_16x16x32_bf16 v[204:207], v[60:63], v[32:35], v[204:207]
    v_or_b32 v44, v12, v84
    v_or_b32 v45, v12, v85
    v_pk_max_u16 v46, v44, v45
    s_waitcnt lgkmcnt(3)
    v_cmp_ne_u32 vcc, 0, v11
    v_mfma_f32_16x16x32_bf16 v[208:211], v[56:59], v[36:39], v[208:211]
    s_waitcnt lgkmcnt(2)
    s_cbranch_vccnz L_spin_C5
L_back_C5:
    ds_read_b128 v[32:35], v4 offset:16384
    ds_read_b64_tr_b16 v[96:97], v7 offset:32768
    ds_read_b64_tr_b16 v[98:99], v7 offset:33792
    v_pk_min_u16 v47, v44, v45
    v_mfma_f32_16x16x32_bf16 v[212:215], v[60:63], v[36:39], v[212:215]
    v_pk_min_u16 v46, v46, v46 op_sel:[0,1] op_sel_hi:[1,0]
    v_pk_max_u16 v46, v46, v47
    v_pk_max_u16 v46, v46, v46 op_sel:[0,1] op_sel_hi:[1,0]
    v_pk_sub_i16 v44, v44, v46
    v_pk_sub_i16 v45, v45, v46
    v_pk_ashrrev_i16 v44, 15, v44 op_sel_hi:[0,1]
    v_mfma_f32_16x16x32_bf16 v[216:219], v[56:59], v[40:43], v[216:219]
    ds_read_b128 v[36:39], v4 offset:18432
    ds_read_b64_tr_b16 v[100:101], v7 offset:32776
    ds_read_b64_tr_b16 v[102:103], v7 offset:33800
    v_pk_ashrrev_i16 v45, 15, v45 op_sel_hi:[0,1]
    v_bfi_b32 v84, v44, 0, v84
    v_mfma_f32_16x16x32_bf16 v[220:223], v[60:63], v[40:43], v[220:223]
    v_bfi_b32 v85, v45, 0, v85
    v_or_b32 v44, v12, v86
    v_or_b32 v45, v12, v87
    v_pk_max_u16 v46, v44, v45
    v_pk_min_u16 v47, v44, v45
    v_mfma_f32_16x16x32_bf16 v[224:227], v[56:59], v[16:19], v[224:227]
    ds_read_b128 v[40:43], v4 offset:20480
    ds_read_b64_tr_b16 v[104:105], v7 offset:40960
    ds_read_b64_tr_b16 v[106:107], v7 offset:41984
    v_pk_min_u16 v46, v46, v46 op_sel:[0,1] op_sel_hi:[1,0]
    v_pk_max_u16 v46, v46, v47
    v_mfma_f32_16x16x32_bf16 v[228:231], v[60:63], v[16:19], v[228:231]
    v_pk_max_u16 v46, v46, v46 op_sel:[0,1] op_sel_hi:[1,0]
    v_pk_sub_i16 v44, v44, v46
    v_pk_sub_i16 v45, v45, v46
    v_pk_ashrrev_i16 v44, 15, v44 op_sel_hi:[0,1]
    v_pk_ashrrev_i16 v45, 15, v45 op_sel_hi:[0,1]
    v_mfma_f32_16x16x32_bf16 v[232:235], v[56:59], v[20:23], v[232:235]
    s_waitcnt lgkmcnt(8)
    s_nop 0
    ds_read_b128 v[16:19], v4 offset:22528
    ds_read_b64_tr_b16 v[108:109], v7 offset:40968
    ds_read_b64_tr_b16 v[110:111], v7 offset:41992
    v_bfi_b32 v86, v44, 0, v86
    v_bfi_b32 v87, v45, 0, v87
    v_mfma_f32_16x16x32_bf16 v[236:239], v[60:63], v[20:23], v[236:239]
    v_or_b32 v44, v12, v88
    v_or_b32 v45, v12, v89
    v_pk_max_u16 v46, v44, v45
    v_pk_min_u16 v47, v44, v45
    v_pk_min_u16 v46, v46, v46 op_sel:[0,1] op_sel_hi:[1,0]
    v_mfma_f32_16x16x32_bf16 v[240:243], v[56:59], v[24:27], v[240:243]
    ds_read_b128 v[20:23], v4 offset:24576
    v_mov_b32_e64 v10, 3
    ds_write_b32 v9, v10
    v_pk_max_u16 v46, v46, v47
    v_pk_max_u16 v46, v46, v46 op_sel:[0,1] op_sel_hi:[1,0]
    v_mfma_f32_16x16x32_bf16 v[244:247], v[60:63], v[24:27], v[244:247]
    v_pk_sub_i16 v44, v44, v46
    v_pk_sub_i16 v45, v45, v46
    v_pk_ashrrev_i16 v44, 15, v44 op_sel_hi:[0,1]
    v_pk_ashrrev_i16 v45, 15, v45 op_sel_hi:[0,1]
    v_bfi_b32 v88, v44, 0, v88
    v_mfma_f32_16x16x32_bf16 v[248:251], v[56:59], v[28:31], v[248:251]
    ds_read_b128 v[24:27], v4 offset:26624
    v_bfi_b32 v89, v45, 0, v89
    v_or_b32 v44, v12, v90
    v_or_b32 v45, v12, v91
    v_mfma_f32_16x16x32_bf16 v[252:255], v[60:63], v[28:31], v[252:255]
    v_pk_max_u16 v46, v44, v45
    v_pk_min_u16 v47, v44, v45
    v_pk_min_u16 v46, v46, v46 op_sel:[0,1] op_sel_hi:[1,0]
    v_pk_max_u16 v46, v46, v47
    v_mfma_f32_16x16x32_bf16 v[128:131], v[64:67], v[32:35], v[128:131]
    s_waitcnt lgkmcnt(5)
    s_nop 0
    ds_read_b128 v[28:31], v4 offset:28672
    v_pk_max_u16 v46, v46, v46 op_sel:[0,1] op_sel_hi:[1,0]
    v_pk_sub_i16 v44, v44, v46
    v_pk_sub_i16 v45, v45, v46
    v_mfma_f32_16x16x32_bf16 v[132:135], v[68:71], v[32:35], v[132:135]
    v_pk_ashrrev_i16 v44, 15, v44 op_sel_hi:[0,1]
    v_pk_ashrrev_i16 v45, 15, v45 op_sel_hi:[0,1]
    v_bfi_b32 v90, v44, 0, v90
    v_bfi_b32 v91, v45, 0, v91
    v_mfma_f32_16x16x32_bf16 v[136:139], v[64:67], v[36:39], v[136:139]
    ds_read_b128 v[32:35], v4 offset:30720
    v_or_b32 v44, v12, v92
    v_or_b32 v45, v12, v93
    v_pk_max_u16 v46, v44, v45
    v_mfma_f32_16x16x32_bf16 v[140:143], v[68:71], v[36:39], v[140:143]
    v_pk_min_u16 v47, v44, v45
    v_pk_min_u16 v46, v46, v46 op_sel:[0,1] op_sel_hi:[1,0]
    v_pk_max_u16 v46, v46, v47
    v_pk_max_u16 v46, v46, v46 op_sel:[0,1] op_sel_hi:[1,0]
    v_mfma_f32_16x16x32_bf16 v[144:147], v[64:67], v[40:43], v[144:147]
    ds_read_b128 v[36:39], v5 offset:16384
    v_pk_sub_i16 v44, v44, v46
    v_pk_sub_i16 v45, v45, v46
    v_pk_ashrrev_i16 v44, 15, v44 op_sel_hi:[0,1]
    v_mfma_f32_16x16x32_bf16 v[148:151], v[68:71], v[40:43], v[148:151]
    v_pk_ashrrev_i16 v45, 15, v45 op_sel_hi:[0,1]
    v_bfi_b32 v92, v44, 0, v92
    v_bfi_b32 v93, v45, 0, v93
    v_or_b32_e64 v44, v12, v94
    v_mfma_f32_16x16x32_bf16 v[152:155], v[64:67], v[16:19], v[152:155]
    s_waitcnt lgkmcnt(2)
    ds_read_b128 v[40:43], v5 offset:18432
    v_or_b32 v45, v12, v95
    v_pk_max_u16 v46, v44, v45
    v_pk_min_u16 v47, v44, v45
    v_mfma_f32_16x16x32_bf16 v[156:159], v[68:71], v[16:19], v[156:159]
    v_pk_min_u16 v46, v46, v46 op_sel:[0,1] op_sel_hi:[1,0]
    v_pk_max_u16 v46, v46, v47
    v_pk_max_u16 v46, v46, v46 op_sel:[0,1] op_sel_hi:[1,0]
    v_pk_sub_i16 v44, v44, v46
    v_mfma_f32_16x16x32_bf16 v[160:163], v[64:67], v[20:23], v[160:163]
    ds_read_b128 v[16:19], v5 offset:20480
    v_pk_sub_i16 v45, v45, v46
    v_pk_ashrrev_i16 v44, 15, v44 op_sel_hi:[0,1]
    v_pk_ashrrev_i16 v45, 15, v45 op_sel_hi:[0,1]
    v_mfma_f32_16x16x32_bf16 v[164:167], v[68:71], v[20:23], v[164:167]
    v_bfi_b32 v94, v44, 0, v94
    v_bfi_b32 v95, v45, 0, v95
    v_or_b32 v44, v12, v96
    v_or_b32 v45, v12, v97
    v_mfma_f32_16x16x32_bf16 v[168:171], v[64:67], v[24:27], v[168:171]
    ds_read_b128 v[20:23], v5 offset:22528
    v_pk_max_u16 v46, v44, v45
    v_pk_min_u16 v47, v44, v45
    v_pk_min_u16 v46, v46, v46 op_sel:[0,1] op_sel_hi:[1,0]
    v_mfma_f32_16x16x32_bf16 v[172:175], v[68:71], v[24:27], v[172:175]
    v_pk_max_u16 v46, v46, v47
    v_pk_max_u16 v46, v46, v46 op_sel:[0,1] op_sel_hi:[1,0]
    v_pk_sub_i16 v44, v44, v46
    v_pk_sub_i16 v45, v45, v46
    v_mfma_f32_16x16x32_bf16 v[176:179], v[64:67], v[28:31], v[176:179]
    s_waitcnt lgkmcnt(2)
    s_nop 0
    ds_read_b128 v[24:27], v5 offset:24576
    v_pk_ashrrev_i16 v44, 15, v44 op_sel_hi:[0,1]
    v_pk_ashrrev_i16 v45, 15, v45 op_sel_hi:[0,1]
    v_bfi_b32 v96, v44, 0, v96
    v_mfma_f32_16x16x32_bf16 v[180:183], v[68:71], v[28:31], v[180:183]
    v_bfi_b32 v97, v45, 0, v97
    v_or_b32 v44, v12, v98
    v_or_b32 v45, v12, v99
    v_pk_max_u16 v46, v44, v45
    v_mfma_f32_16x16x32_bf16 v[184:187], v[64:67], v[32:35], v[184:187]
    ds_read_b32 v11, v8 offset:108
    ds_read_b128 v[28:31], v5 offset:26624
    v_pk_min_u16 v47, v44, v45
    v_pk_min_u16 v46, v46, v46 op_sel:[0,1] op_sel_hi:[1,0]
    v_pk_max_u16 v46, v46, v47
    v_mfma_f32_16x16x32_bf16 v[188:191], v[68:71], v[32:35], v[188:191]
    v_pk_max_u16 v46, v46, v46 op_sel:[0,1] op_sel_hi:[1,0]
    v_pk_sub_i16 v44, v44, v46
    v_pk_sub_i16 v45, v45, v46
    v_pk_ashrrev_i16 v44, 15, v44 op_sel_hi:[0,1]
    v_mfma_f32_16x16x32_bf16 v[128:131], v[72:75], v[36:39], v[128:131]
    ds_read_b128 v[32:35], v5 offset:28672
    v_pk_ashrrev_i16 v45, 15, v45 op_sel_hi:[0,1]
    v_bfi_b32 v98, v44, 0, v98
    v_bfi_b32 v99, v45, 0, v99
    v_mfma_f32_16x16x32_bf16 v[132:135], v[76:79], v[36:39], v[132:135]
    v_or_b32 v44, v12, v100
    v_or_b32 v45, v12, v101
    v_pk_max_u16 v46, v44, v45
    v_pk_min_u16 v47, v44, v45
    v_mfma_f32_16x16x32_bf16 v[136:139], v[72:75], v[40:43], v[136:139]
    s_waitcnt lgkmcnt(3)
    s_nop 0
    ds_read_b128 v[36:39], v5 offset:30720
    v_pk_min_u16 v46, v46, v46 op_sel:[0,1] op_sel_hi:[1,0]
    v_pk_max_u16 v46, v46, v47
    v_pk_max_u16 v46, v46, v46 op_sel:[0,1] op_sel_hi:[1,0]
    v_pk_sub_i16 v44, v44, v46
    v_mfma_f32_16x16x32_bf16 v[140:143], v[76:79], v[40:43], v[140:143]
    v_pk_sub_i16 v45, v45, v46
    v_pk_ashrrev_i16 v44, 15, v44 op_sel_hi:[0,1]
    v_pk_ashrrev_i16 v45, 15, v45 op_sel_hi:[0,1]
    s_waitcnt lgkmcnt(3)
    v_cmp_ne_u32 vcc, 0, v11
    v_mfma_f32_16x16x32_bf16 v[144:147], v[72:75], v[16:19], v[144:147]
    s_cbranch_vccnz L_spin_C6
L_back_C6:
    s_nop 0
    ds_read_b128 v[40:43], v4 offset:49152
    ds_read_b64_tr_b16 v[112:113], v6 offset:0
    ds_read_b64_tr_b16 v[114:115], v6 offset:1024
    v_bfi_b32 v100, v44, 0, v100
    v_mfma_f32_16x16x32_bf16 v[148:151], v[76:79], v[16:19], v[148:151]
    v_bfi_b32 v101, v45, 0, v101
    v_or_b32 v44, v12, v102
    v_or_b32 v45, v12, v103
    v_pk_max_u16 v46, v44, v45
    v_pk_min_u16 v47, v44, v45
    v_pk_min_u16 v46, v46, v46 op_sel:[0,1] op_sel_hi:[1,0]
    v_mfma_f32_16x16x32_bf16 v[152:155], v[72:75], v[20:23], v[152:155]
    ds_read_b128 v[16:19], v4 offset:51200
    ds_read_b64_tr_b16 v[116:117], v6 offset:8
    ds_read_b64_tr_b16 v[118:119], v6 offset:1032
    v_pk_max_u16 v46, v46, v47
    v_pk_max_u16 v46, v46, v46 op_sel:[0,1] op_sel_hi:[1,0]
    v_mfma_f32_16x16x32_bf16 v[156:159], v[76:79], v[20:23], v[156:159]
    v_pk_sub_i16 v44, v44, v46
    v_pk_sub_i16 v45, v45, v46
    v_pk_ashrrev_i16 v44, 15, v44 op_sel_hi:[0,1]
    v_pk_ashrrev_i16 v45, 15, v45 op_sel_hi:[0,1]
    v_bfi_b32 v102, v44, 0, v102
    v_mfma_f32_16x16x32_bf16 v[160:163], v[72:75], v[24:27], v[160:163]
    s_waitcnt lgkmcnt(6)
    ds_read_b128 v[20:23], v4 offset:53248
    ds_read_b64_tr_b16 v[120:121], v6 offset:8192
    ds_read_b64_tr_b16 v[122:123], v6 offset:9216
    v_bfi_b32 v103, v45, 0, v103
    v_or_b32 v44, v12, v104
    v_mfma_f32_16x16x32_bf16 v[164:167], v[76:79], v[24:27], v[164:167]
    v_or_b32_e64 v45, v12, v105
    v_pk_max_u16 v46, v44, v45
    v_pk_min_u16 v47, v44, v45
    v_pk_min_u16 v46, v46, v46 op_sel:[0,1] op_sel_hi:[1,0]
    v_pk_max_u16 v46, v46, v47
    v_mfma_f32_16x16x32_bf16 v[168:171], v[72:75], v[28:31], v[168:171]
    ds_read_b128 v[24:27], v4 offset:55296
    ds_read_b64_tr_b16 v[124:125], v6 offset:8200
    ds_read_b64_tr_b16 v[126:127], v6 offset:9224
    v_pk_max_u16 v46, v46, v46 op_sel:[0,1] op_sel_hi:[1,0]
    v_pk_sub_i16 v44, v44, v46
    v_mfma_f32_16x16x32_bf16 v[172:175], v[76:79], v[28:31], v[172:175]
    v_pk_sub_i16 v45, v45, v46
    v_pk_ashrrev_i16 v44, 15, v44 op_sel_hi:[0,1]
    v_pk_ashrrev_i16 v45, 15, v45 op_sel_hi:[0,1]
    v_bfi_b32 v104, v44, 0, v104
    v_bfi_b32 v105, v45, 0, v105
    v_mfma_f32_16x16x32_bf16 v[176:179], v[72:75], v[32:35], v[176:179]
    ds_read_b128 v[28:31], v4 offset:57344
    v_mov_b32_e64 v10, 4
    ds_write_b32 v9, v10
    v_or_b32 v44, v12, v106
    v_or_b32 v45, v12, v107
    v_mfma_f32_16x16x32_bf16 v[180:183], v[76:79], v[32:35], v[180:183]
    v_pk_max_u16 v46, v44, v45
    v_pk_min_u16 v47, v44, v45
    v_pk_min_u16 v46, v46, v46 op_sel:[0,1] op_sel_hi:[1,0]
    v_pk_max_u16 v46, v46, v47
    v_pk_max_u16 v46, v46, v46 op_sel:[0,1] op_sel_hi:[1,0]
    v_mfma_f32_16x16x32_bf16 v[184:187], v[72:75], v[36:39], v[184:187]
    s_waitcnt lgkmcnt(7)
    s_nop 0
    ds_read_b128 v[32:35], v4 offset:59392
    v_pk_sub_i16 v44, v44, v46
    v_pk_sub_i16 v45, v45, v46
    v_pk_ashrrev_i16 v44, 15, v44 op_sel_hi:[0,1]
    v_mfma_f32_16x16x32_bf16 v[188:191], v[76:79], v[36:39], v[188:191]
    v_pk_ashrrev_i16 v45, 15, v45 op_sel_hi:[0,1]
    v_bfi_b32 v106, v44, 0, v106
    v_bfi_b32 v107, v45, 0, v107
    v_or_b32_e64 v44, v12, v108
    v_mfma_f32_16x16x32_bf16 v[192:195], v[64:67], v[40:43], v[192:195]
    ds_read_b128 v[36:39], v4 offset:61440
    v_or_b32_e64 v45, v12, v109
    v_pk_max_u16 v46, v44, v45
    v_pk_min_u16 v47, v44, v45
    v_mfma_f32_16x16x32_bf16 v[196:199], v[68:71], v[40:43], v[196:199]
    v_pk_min_u16 v46, v46, v46 op_sel:[0,1] op_sel_hi:[1,0]
    v_pk_max_u16 v46, v46, v47
    v_pk_max_u16 v46, v46, v46 op_sel:[0,1] op_sel_hi:[1,0]
    v_pk_sub_i16 v44, v44, v46
    v_mfma_f32_16x16x32_bf16 v[200:203], v[64:67], v[16:19], v[200:203]
    ds_read_b128 v[40:43], v4 offset:63488
    v_pk_sub_i16 v45, v45, v46
    v_pk_ashrrev_i16 v44, 15, v44 op_sel_hi:[0,1]
    v_pk_ashrrev_i16 v45, 15, v45 op_sel_hi:[0,1]
    v_mfma_f32_16x16x32_bf16 v[204:207], v[68:71], v[16:19], v[204:207]
    v_bfi_b32 v108, v44, 0, v108
    v_bfi_b32 v109, v45, 0, v109
    v_or_b32 v44, v12, v110
    v_or_b32 v45, v12, v111
    v_mfma_f32_16x16x32_bf16 v[208:211], v[64:67], v[20:23], v[208:211]
    s_waitcnt lgkmcnt(2)
    s_nop 0
    ds_read_b128 v[16:19], v5 offset:49152
    v_pk_max_u16 v46, v44, v45
    v_pk_min_u16 v47, v44, v45
    v_pk_min_u16 v46, v46, v46 op_sel:[0,1] op_sel_hi:[1,0]
    v_mfma_f32_16x16x32_bf16 v[212:215], v[68:71], v[20:23], v[212:215]
    v_pk_max_u16 v46, v46, v47
    v_pk_max_u16 v46, v46, v46 op_sel:[0,1] op_sel_hi:[1,0]
    v_pk_sub_i16 v44, v44, v46
    v_pk_sub_i16 v45, v45, v46
    v_mfma_f32_16x16x32_bf16 v[216:219], v[64:67], v[24:27], v[216:219]
    ds_read_b128 v[20:23], v5 offset:51200
    v_pk_ashrrev_i16 v44, 15, v44 op_sel_hi:[0,1]
    v_pk_ashrrev_i16 v45, 15, v45 op_sel_hi:[0,1]
    v_bfi_b32 v110, v44, 0, v110
    v_mfma_f32_16x16x32_bf16 v[220:223], v[68:71], v[24:27], v[220:223]
    v_bfi_b32 v111, v45, 0, v111
    v_or_b32 v44, v12, v112
    v_or_b32 v45, v12, v113
    v_pk_max_u16 v46, v44, v45
    v_mfma_f32_16x16x32_bf16 v[224:227], v[64:67], v[28:31], v[224:227]
    ds_read_b128 v[24:27], v5 offset:53248
    v_pk_min_u16 v47, v44, v45
    v_pk_min_u16 v46, v46, v46 op_sel:[0,1] op_sel_hi:[1,0]
    v_pk_max_u16 v46, v46, v47
    v_mfma_f32_16x16x32_bf16 v[228:231], v[68:71], v[28:31], v[228:231]
    v_pk_max_u16 v46, v46, v46 op_sel:[0,1] op_sel_hi:[1,0]
    v_pk_sub_i16 v44, v44, v46
    v_pk_sub_i16 v45, v45, v46
    v_pk_ashrrev_i16 v44, 15, v44 op_sel_hi:[0,1]
    v_mfma_f32_16x16x32_bf16 v[232:235], v[64:67], v[32:35], v[232:235]
    s_waitcnt lgkmcnt(2)
    s_nop 0
    ds_read_b128 v[28:31], v5 offset:55296
    v_pk_ashrrev_i16 v45, 15, v45 op_sel_hi:[0,1]
    v_bfi_b32 v112, v44, 0, v112
    v_bfi_b32 v113, v45, 0, v113
    v_mfma_f32_16x16x32_bf16 v[236:239], v[68:71], v[32:35], v[236:239]
    v_or_b32 v44, v12, v114
    v_or_b32 v45, v12, v115
    v_pk_max_u16 v46, v44, v45
    v_pk_min_u16 v47, v44, v45
    v_mfma_f32_16x16x32_bf16 v[240:243], v[64:67], v[36:39], v[240:243]
    ds_read_b128 v[32:35], v5 offset:57344
    v_pk_min_u16 v46, v46, v46 op_sel:[0,1] op_sel_hi:[1,0]
    v_pk_max_u16 v46, v46, v47
    v_pk_max_u16 v46, v46, v46 op_sel:[0,1] op_sel_hi:[1,0]
    v_mfma_f32_16x16x32_bf16 v[244:247], v[68:71], v[36:39], v[244:247]
    v_pk_sub_i16 v44, v44, v46
    v_pk_sub_i16 v45, v45, v46
    v_pk_ashrrev_i16 v44, 15, v44 op_sel_hi:[0,1]
    v_pk_ashrrev_i16 v45, 15, v45 op_sel_hi:[0,1]
    v_mfma_f32_16x16x32_bf16 v[248:251], v[64:67], v[40:43], v[248:251]
    ds_read_b32 v11, v8 offset:104
    ds_read_b128 v[36:39], v5 offset:59392
    v_bfi_b32 v114, v44, 0, v114
    v_bfi_b32 v115, v45, 0, v115
    v_or_b32_e64 v44, v12, v116
    v_mfma_f32_16x16x32_bf16 v[252:255], v[68:71], v[40:43], v[252:255]
    v_or_b32_e64 v45, v12, v117
    v_pk_max_u16 v46, v44, v45
    v_pk_min_u16 v47, v44, v45
    v_pk_min_u16 v46, v46, v46 op_sel:[0,1] op_sel_hi:[1,0]
    v_mfma_f32_16x16x32_bf16 v[192:195], v[72:75], v[16:19], v[192:195]
    s_waitcnt lgkmcnt(3)
    s_nop 0
    ds_read_b128 v[40:43], v5 offset:61440
    v_pk_max_u16 v46, v46, v47
    v_pk_max_u16 v46, v46, v46 op_sel:[0,1] op_sel_hi:[1,0]
    v_pk_sub_i16 v44, v44, v46
    v_mfma_f32_16x16x32_bf16 v[196:199], v[76:79], v[16:19], v[196:199]
    v_pk_sub_i16 v45, v45, v46
    v_pk_ashrrev_i16 v44, 15, v44 op_sel_hi:[0,1]
    v_pk_ashrrev_i16 v45, 15, v45 op_sel_hi:[0,1]
    v_bfi_b32 v116, v44, 0, v116
    v_mfma_f32_16x16x32_bf16 v[200:203], v[72:75], v[20:23], v[200:203]
    ds_read_b128 v[16:19], v5 offset:63488
    v_bfi_b32 v117, v45, 0, v117
    v_or_b32 v44, v12, v118
    v_or_b32 v45, v12, v119
    v_pk_max_u16 v46, v44, v45
    v_mfma_f32_16x16x32_bf16 v[204:207], v[76:79], v[20:23], v[204:207]
    v_pk_min_u16 v47, v44, v45
    v_pk_min_u16 v46, v46, v46 op_sel:[0,1] op_sel_hi:[1,0]
    v_pk_max_u16 v46, v46, v47
    s_waitcnt lgkmcnt(3)
    v_cmp_ne_u32 vcc, 0, v11
    v_mfma_f32_16x16x32_bf16 v[208:211], v[72:75], v[24:27], v[208:211]
    s_cbranch_vccnz L_spin_C7
L_back_C7:
    s_nop 0
    ds_read_b128 v[20:23], v2 offset:32768
    ds_read_b64_tr_b16 v[48:49], v6 offset:16384
    ds_read_b64_tr_b16 v[50:51], v6 offset:17408
    v_pk_max_u16 v46, v46, v46 op_sel:[0,1] op_sel_hi:[1,0]
    v_mfma_f32_16x16x32_bf16 v[212:215], v[76:79], v[24:27], v[212:215]
    v_pk_sub_i16 v44, v44, v46
    v_pk_sub_i16 v45, v45, v46
    v_pk_ashrrev_i16 v44, 15, v44 op_sel_hi:[0,1]
    v_pk_ashrrev_i16 v45, 15, v45 op_sel_hi:[0,1]
    v_bfi_b32 v118, v44, 0, v118
    v_bfi_b32 v119, v45, 0, v119
    v_mfma_f32_16x16x32_bf16 v[216:219], v[72:75], v[28:31], v[216:219]
    s_waitcnt lgkmcnt(4)
    ds_read_b128 v[24:27], v2 offset:34816
    ds_read_b64_tr_b16 v[52:53], v6 offset:16392
    ds_read_b64_tr_b16 v[54:55], v6 offset:17416
    v_or_b32 v44, v12, v120
    v_or_b32_e64 v45, v12, v121
    v_mfma_f32_16x16x32_bf16 v[220:223], v[76:79], v[28:31], v[220:223]
    v_pk_max_u16 v46, v44, v45
    v_pk_min_u16 v47, v44, v45
    v_pk_min_u16 v46, v46, v46 op_sel:[0,1] op_sel_hi:[1,0]
    v_pk_max_u16 v46, v46, v47
    v_pk_max_u16 v46, v46, v46 op_sel:[0,1] op_sel_hi:[1,0]
    v_mfma_f32_16x16x32_bf16 v[224:227], v[72:75], v[32:35], v[224:227]
    ds_read_b128 v[28:31], v2 offset:36864
    ds_read_b64_tr_b16 v[56:57], v6 offset:24576
    ds_read_b64_tr_b16 v[58:59], v6 offset:25600
    v_pk_sub_i16 v44, v44, v46
    v_pk_sub_i16 v45, v45, v46
    v_mfma_f32_16x16x32_bf16 v[228:231], v[76:79], v[32:35], v[228:231]
    v_pk_ashrrev_i16 v44, 15, v44 op_sel_hi:[0,1]
    v_pk_ashrrev_i16 v45, 15, v45 op_sel_hi:[0,1]
    v_bfi_b32 v120, v44, 0, v120
    v_bfi_b32 v121, v45, 0, v121
    v_or_b32_e64 v44, v12, v122
    v_mfma_f32_16x16x32_bf16 v[232:235], v[72:75], v[36:39], v[232:235]
    ds_read_b128 v[32:35], v2 offset:38912
    ds_read_b64_tr_b16 v[60:61], v6 offset:24584
    ds_read_b64_tr_b16 v[62:63], v6 offset:25608
    v_or_b32_e64 v45, v12, v123
    v_pk_max_u16 v46, v44, v45
    v_mfma_f32_16x16x32_bf16 v[236:239], v[76:79], v[36:39], v[236:239]
    v_pk_min_u16 v47, v44, v45
    v_pk_min_u16 v46, v46, v46 op_sel:[0,1] op_sel_hi:[1,0]
    v_pk_max_u16 v46, v46, v47
    v_pk_max_u16 v46, v46, v46 op_sel:[0,1] op_sel_hi:[1,0]
    v_pk_sub_i16 v44, v44, v46
    v_mfma_f32_16x16x32_bf16 v[240:243], v[72:75], v[40:43], v[240:243]
    s_waitcnt lgkmcnt(8)
    ds_read_b128 v[36:39], v2 offset:40960
    v_mov_b32 v10, 5
    ds_write_b32 v9, v10
    v_pk_sub_i16 v45, v45, v46
    v_pk_ashrrev_i16 v44, 15, v44 op_sel_hi:[0,1]
    v_mfma_f32_16x16x32_bf16 v[244:247], v[76:79], v[40:43], v[244:247]
    v_pk_ashrrev_i16 v45, 15, v45 op_sel_hi:[0,1]
    v_bfi_b32 v122, v44, 0, v122
    v_bfi_b32 v123, v45, 0, v123
    v_or_b32 v44, v12, v124
    v_or_b32 v45, v12, v125
    v_mfma_f32_16x16x32_bf16 v[248:251], v[72:75], v[16:19], v[248:251]
    ds_read_b128 v[40:43], v2 offset:43008
    v_pk_max_u16 v46, v44, v45
    v_pk_min_u16 v47, v44, v45
    v_pk_min_u16 v46, v46, v46 op_sel:[0,1] op_sel_hi:[1,0]
    v_mfma_f32_16x16x32_bf16 v[252:255], v[76:79], v[16:19], v[252:255]
    v_pk_max_u16 v46, v46, v47
    v_pk_max_u16 v46, v46, v46 op_sel:[0,1] op_sel_hi:[1,0]
    v_pk_sub_i16 v44, v44, v46
    v_pk_sub_i16 v45, v45, v46
    v_mfma_f32_16x16x32_bf16 v[128:131], v[80:83], v[20:23], v[128:131]
    ds_read_b128 v[16:19], v2 offset:45056
    v_pk_ashrrev_i16 v44, 15, v44 op_sel_hi:[0,1]
    v_pk_ashrrev_i16 v45, 15, v45 op_sel_hi:[0,1]
    v_bfi_b32 v124, v44, 0, v124
    v_mfma_f32_16x16x32_bf16 v[132:135], v[84:87], v[20:23], v[132:135]
    v_bfi_b32 v125, v45, 0, v125
    v_or_b32 v44, v12, v126
    v_or_b32 v45, v12, v127
    v_pk_max_u16 v46, v44, v45
    v_mfma_f32_16x16x32_bf16 v[136:139], v[80:83], v[24:27], v[136:139]
    s_waitcnt lgkmcnt(3)
    s_nop 0
    ds_read_b128 v[20:23], v2 offset:47104
    v_pk_min_u16 v47, v44, v45
    v_pk_min_u16 v46, v46, v46 op_sel:[0,1] op_sel_hi:[1,0]
    v_pk_max_u16 v46, v46, v47
    v_mfma_f32_16x16x32_bf16 v[140:143], v[84:87], v[24:27], v[140:143]
    v_pk_max_u16 v46, v46, v46 op_sel:[0,1] op_sel_hi:[1,0]
    v_pk_sub_i16 v44, v44, v46
    v_pk_sub_i16 v45, v45, v46
    v_pk_ashrrev_i16 v44, 15, v44 op_sel_hi:[0,1]
    v_mfma_f32_16x16x32_bf16 v[144:147], v[80:83], v[28:31], v[144:147]
    ds_read_b128 v[24:27], v3 offset:32768
    v_pk_ashrrev_i16 v45, 15, v45 op_sel_hi:[0,1]
    v_bfi_b32 v126, v44, 0, v126
    v_bfi_b32 v127, v45, 0, v127
    v_mfma_f32_16x16x32_bf16 v[148:151], v[84:87], v[28:31], v[148:151]
    v_or_b32 v44, v12, v48
    v_or_b32 v45, v12, v49
    v_pk_max_u16 v46, v44, v45
    v_pk_min_u16 v47, v44, v45
    v_mfma_f32_16x16x32_bf16 v[152:155], v[80:83], v[32:35], v[152:155]
    ds_read_b128 v[28:31], v3 offset:34816
    v_pk_min_u16 v46, v46, v46 op_sel:[0,1] op_sel_hi:[1,0]
    v_pk_max_u16 v46, v46, v47
    v_pk_max_u16 v46, v46, v46 op_sel:[0,1] op_sel_hi:[1,0]
    v_mfma_f32_16x16x32_bf16 v[156:159], v[84:87], v[32:35], v[156:159]
    v_pk_sub_i16 v44, v44, v46
    v_pk_sub_i16 v45, v45, v46
    v_pk_ashrrev_i16 v44, 15, v44 op_sel_hi:[0,1]
    v_pk_ashrrev_i16 v45, 15, v45 op_sel_hi:[0,1]
    v_mfma_f32_16x16x32_bf16 v[160:163], v[80:83], v[36:39], v[160:163]
    s_waitcnt lgkmcnt(2)
    ds_read_b128 v[32:35], v3 offset:36864
    v_bfi_b32 v48, v44, 0, v48
    v_bfi_b32 v49, v45, 0, v49
    v_or_b32 v44, v12, v50
    v_mfma_f32_16x16x32_bf16 v[164:167], v[84:87], v[36:39], v[164:167]
    v_or_b32_e64 v45, v12, v51
    v_pk_max_u16 v46, v44, v45
    v_pk_min_u16 v47, v44, v45
    v_pk_min_u16 v46, v46, v46 op_sel:[0,1] op_sel_hi:[1,0]
    v_mfma_f32_16x16x32_bf16 v[168:171], v[80:83], v[40:43], v[168:171]
    ds_read_b128 v[36:39], v3 offset:38912
    v_pk_max_u16 v46, v46, v47
    v_pk_max_u16 v46, v46, v46 op_sel:[0,1] op_sel_hi:[1,0]
    v_pk_sub_i16 v44, v44, v46
    v_mfma_f32_16x16x32_bf16 v[172:175], v[84:87], v[40:43], v[172:175]
    v_pk_sub_i16 v45, v45, v46
    v_pk_ashrrev_i16 v44, 15, v44 op_sel_hi:[0,1]
    v_pk_ashrrev_i16 v45, 15, v45 op_sel_hi:[0,1]
    v_bfi_b32 v50, v44, 0, v50
    v_mfma_f32_16x16x32_bf16 v[176:179], v[80:83], v[16:19], v[176:179]
    ds_read_b128 v[40:43], v3 offset:40960
    v_bfi_b32 v51, v45, 0, v51
    v_or_b32 v44, v12, v52
    v_or_b32 v45, v12, v53
    v_mfma_f32_16x16x32_bf16 v[180:183], v[84:87], v[16:19], v[180:183]
    v_pk_max_u16 v46, v44, v45
    v_pk_min_u16 v47, v44, v45
    v_pk_min_u16 v46, v46, v46 op_sel:[0,1] op_sel_hi:[1,0]
    v_pk_max_u16 v46, v46, v47
    v_mfma_f32_16x16x32_bf16 v[184:187], v[80:83], v[20:23], v[184:187]
    s_waitcnt lgkmcnt(2)
    s_nop 0
    ds_read_b32 v11, v8 offset:100
    ds_read_b128 v[16:19], v3 offset:43008
    v_pk_max_u16 v46, v46, v46 op_sel:[0,1] op_sel_hi:[1,0]
    v_pk_sub_i16 v44, v44, v46
    v_mfma_f32_16x16x32_bf16 v[188:191], v[84:87], v[20:23], v[188:191]
    v_pk_sub_i16 v45, v45, v46
    v_pk_ashrrev_i16 v44, 15, v44 op_sel_hi:[0,1]
    v_pk_ashrrev_i16 v45, 15, v45 op_sel_hi:[0,1]
    v_bfi_b32 v52, v44, 0, v52
    v_bfi_b32 v53, v45, 0, v53
    v_mfma_f32_16x16x32_bf16 v[128:131], v[88:91], v[24:27], v[128:131]
    ds_read_b128 v[20:23], v3 offset:45056
    v_or_b32 v44, v12, v54
    v_or_b32 v45, v12, v55
    v_pk_max_u16 v46, v44, v45
    v_mfma_f32_16x16x32_bf16 v[132:135], v[92:95], v[24:27], v[132:135]
    v_pk_min_u16 v47, v44, v45
    v_pk_min_u16 v46, v46, v46 op_sel:[0,1] op_sel_hi:[1,0]
    v_pk_max_u16 v46, v46, v47
    v_pk_max_u16 v46, v46, v46 op_sel:[0,1] op_sel_hi:[1,0]
    v_mfma_f32_16x16x32_bf16 v[136:139], v[88:91], v[28:31], v[136:139]
    ds_read_b128 v[24:27], v3 offset:47104
    v_pk_sub_i16 v44, v44, v46
    v_pk_sub_i16 v45, v45, v46
    v_pk_ashrrev_i16 v44, 15, v44 op_sel_hi:[0,1]
    v_pk_ashrrev_i16 v45, 15, v45 op_sel_hi:[0,1]
    v_mfma_f32_16x16x32_bf16 v[140:143], v[92:95], v[28:31], v[140:143]
    v_bfi_b32 v54, v44, 0, v54
    v_bfi_b32 v55, v45, 0, v55
    v_or_b32 v44, v12, v56
    s_waitcnt lgkmcnt(3)
    v_cmp_ne_u32 vcc, 0, v11
    v_mfma_f32_16x16x32_bf16 v[144:147], v[88:91], v[32:35], v[144:147]
    s_waitcnt lgkmcnt(2)
    s_cbranch_vccnz L_spin_C8
L_back_C8:
    ds_read_b128 v[28:31], v4 offset:0
    ds_read_b64_tr_b16 v[64:65], v6 offset:49152
    ds_read_b64_tr_b16 v[66:67], v6 offset:50176
    v_or_b32 v45, v12, v57
    v_mfma_f32_16x16x32_bf16 v[148:151], v[92:95], v[32:35], v[148:151]
    v_pk_max_u16 v46, v44, v45
    v_pk_min_u16 v47, v44, v45
    v_pk_min_u16 v46, v46, v46 op_sel:[0,1] op_sel_hi:[1,0]
    v_pk_max_u16 v46, v46, v47
    v_pk_max_u16 v46, v46, v46 op_sel:[0,1] op_sel_hi:[1,0]
    v_pk_sub_i16 v44, v44, v46
    v_mfma_f32_16x16x32_bf16 v[152:155], v[88:91], v[36:39], v[152:155]
    ds_read_b128 v[32:35], v4 offset:2048
    ds_read_b64_tr_b16 v[68:69], v6 offset:49160
    ds_read_b64_tr_b16 v[70:71], v6 offset:50184
    v_pk_sub_i16 v45, v45, v46
    v_pk_ashrrev_i16 v44, 15, v44 op_sel_hi:[0,1]
    v_mfma_f32_16x16x32_bf16 v[156:159], v[92:95], v[36:39], v[156:159]
    v_pk_ashrrev_i16 v45, 15, v45 op_sel_hi:[0,1]
    v_bfi_b32 v56, v44, 0, v56
    v_bfi_b32 v57, v45, 0, v57
    v_or_b32 v44, v12, v58
    v_or_b32 v45, v12, v59
    v_mfma_f32_16x16x32_bf16 v[160:163], v[88:91], v[40:43], v[160:163]
    ds_read_b128 v[36:39], v4 offset:4096
    ds_read_b64_tr_b16 v[72:73], v6 offset:57344
    ds_read_b64_tr_b16 v[74:75], v6 offset:58368
    v_pk_max_u16 v46, v44, v45
    v_pk_min_u16 v47, v44, v45
    v_mfma_f32_16x16x32_bf16 v[164:167], v[92:95], v[40:43], v[164:167]
    v_pk_min_u16 v46, v46, v46 op_sel:[0,1] op_sel_hi:[1,0]
    v_pk_max_u16 v46, v46, v47
    v_pk_max_u16 v46, v46, v46 op_sel:[0,1] op_sel_hi:[1,0]
    v_pk_sub_i16 v44, v44, v46
    v_pk_sub_i16 v45, v45, v46
    v_mfma_f32_16x16x32_bf16 v[168:171], v[88:91], v[16:19], v[168:171]
    s_waitcnt lgkmcnt(8)
    s_nop 0
    ds_read_b128 v[40:43], v4 offset:6144
    ds_read_b64_tr_b16 v[76:77], v6 offset:57352
    ds_read_b64_tr_b16 v[78:79], v6 offset:58376
    v_pk_ashrrev_i16 v44, 15, v44 op_sel_hi:[0,1]
    v_pk_ashrrev_i16 v45, 15, v45 op_sel_hi:[0,1]
    v_mfma_f32_16x16x32_bf16 v[172:175], v[92:95], v[16:19], v[172:175]
    v_bfi_b32 v58, v44, 0, v58
    v_bfi_b32 v59, v45, 0, v59
    v_or_b32 v44, v12, v60
    v_or_b32 v45, v12, v61
    v_pk_max_u16 v46, v44, v45
    v_mfma_f32_16x16x32_bf16 v[176:179], v[88:91], v[20:23], v[176:179]
    ds_read_b128 v[16:19], v4 offset:8192
    v_mov_b32_e64 v10, 6
    ds_write_b32 v9, v10
    v_pk_min_u16 v47, v44, v45
    v_pk_min_u16 v46, v46, v46 op_sel:[0,1] op_sel_hi:[1,0]
    v_mfma_f32_16x16x32_bf16 v[180:183], v[92:95], v[20:23], v[180:183]
    v_pk_max_u16 v46, v46, v47
    v_pk_max_u16 v46, v46, v46 op_sel:[0,1] op_sel_hi:[1,0]
    v_pk_sub_i16 v44, v44, v46
    v_pk_sub_i16 v45, v45, v46
    v_pk_ashrrev_i16 v44, 15, v44 op_sel_hi:[0,1]
    v_mfma_f32_16x16x32_bf16 v[184:187], v[88:91], v[24:27], v[184:187]
    ds_read_b128 v[20:23], v4 offset:10240
    v_pk_ashrrev_i16 v45, 15, v45 op_sel_hi:[0,1]
    v_bfi_b32 v60, v44, 0, v60
    v_bfi_b32 v61, v45, 0, v61
    v_mfma_f32_16x16x32_bf16 v[188:191], v[92:95], v[24:27], v[188:191]
    v_or_b32 v44, v12, v62
    v_or_b32 v45, v12, v63
    v_pk_max_u16 v46, v44, v45
    v_pk_min_u16 v47, v44, v45
    v_mfma_f32_16x16x32_bf16 v[192:195], v[80:83], v[28:31], v[192:195]
    s_waitcnt lgkmcnt(5)
    s_nop 0
    ds_read_b128 v[24:27], v4 offset:12288
    v_pk_min_u16 v46, v46, v46 op_sel:[0,1] op_sel_hi:[1,0]
    v_pk_max_u16 v46, v46, v47
    v_pk_max_u16 v46, v46, v46 op_sel:[0,1] op_sel_hi:[1,0]
    v_mfma_f32_16x16x32_bf16 v[196:199], v[84:87], v[28:31], v[196:199]
    v_pk_sub_i16 v44, v44, v46
    v_pk_sub_i16 v45, v45, v46
    v_pk_ashrrev_i16 v44, 15, v44 op_sel_hi:[0,1]
    v_pk_ashrrev_i16 v45, 15, v45 op_sel_hi:[0,1]
    v_mfma_f32_16x16x32_bf16 v[200:203], v[80:83], v[32:35], v[200:203]
    ds_read_b128 v[28:31], v4 offset:14336
    v_bfi_b32 v62, v44, 0, v62
    v_bfi_b32 v63, v45, 0, v63
    v_or_b32_e64 v44, v12, v64
    v_mfma_f32_16x16x32_bf16 v[204:207], v[84:87], v[32:35], v[204:207]
    v_or_b32_e64 v45, v12, v65
    v_pk_max_u16 v46, v44, v45
    v_pk_min_u16 v47, v44, v45
    v_pk_min_u16 v46, v46, v46 op_sel:[0,1] op_sel_hi:[1,0]
    v_mfma_f32_16x16x32_bf16 v[208:211], v[80:83], v[36:39], v[208:211]
    ds_read_b128 v[32:35], v5 offset:0
    v_pk_max_u16 v46, v46, v47
    v_pk_max_u16 v46, v46, v46 op_sel:[0,1] op_sel_hi:[1,0]
    v_pk_sub_i16 v44, v44, v46
    v_mfma_f32_16x16x32_bf16 v[212:215], v[84:87], v[36:39], v[212:215]
    v_pk_sub_i16 v45, v45, v46
    v_pk_ashrrev_i16 v44, 15, v44 op_sel_hi:[0,1]
    v_pk_ashrrev_i16 v45, 15, v45 op_sel_hi:[0,1]
    v_bfi_b32 v64, v44, 0, v64
    v_mfma_f32_16x16x32_bf16 v[216:219], v[80:83], v[40:43], v[216:219]
    s_waitcnt lgkmcnt(2)
    ds_read_b128 v[36:39], v5 offset:2048
    v_bfi_b32 v65, v45, 0, v65
    v_or_b32 v44, v12, v66
    v_or_b32_e64 v45, v12, v67
    v_mfma_f32_16x16x32_bf16 v[220:223], v[84:87], v[40:43], v[220:223]
    v_pk_max_u16 v46, v44, v45
    v_pk_min_u16 v47, v44, v45
    v_pk_min_u16 v46, v46, v46 op_sel:[0,1] op_sel_hi:[1,0]
    v_pk_max_u16 v46, v46, v47
    v_mfma_f32_16x16x32_bf16 v[224:227], v[80:83], v[16:19], v[224:227]
    ds_read_b128 v[40:43], v5 offset:4096
    v_pk_max_u16 v46, v46, v46 op_sel:[0,1] op_sel_hi:[1,0]
    v_pk_sub_i16 v44, v44, v46
    v_pk_sub_i16 v45, v45, v46
    v_mfma_f32_16x16x32_bf16 v[228:231], v[84:87], v[16:19], v[228:231]
    v_pk_ashrrev_i16 v44, 15, v44 op_sel_hi:[0,1]
    v_pk_ashrrev_i16 v45, 15, v45 op_sel_hi:[0,1]
    v_bfi_b32 v66, v44, 0, v66
    v_bfi_b32 v67, v45, 0, v67
    v_mfma_f32_16x16x32_bf16 v[232:235], v[80:83], v[20:23], v[232:235]
    ds_read_b128 v[16:19], v5 offset:6144
    v_or_b32 v44, v12, v68
    v_or_b32 v45, v12, v69
    v_pk_max_u16 v46, v44, v45
    v_mfma_f32_16x16x32_bf16 v[236:239], v[84:87], v[20:23], v[236:239]
    v_pk_min_u16 v47, v44, v45
    v_pk_min_u16 v46, v46, v46 op_sel:[0,1] op_sel_hi:[1,0]
    v_pk_max_u16 v46, v46, v47
    v_pk_max_u16 v46, v46, v46 op_sel:[0,1] op_sel_hi:[1,0]
    v_mfma_f32_16x16x32_bf16 v[240:243], v[80:83], v[24:27], v[240:243]
    s_waitcnt lgkmcnt(2)
    s_nop 0
    ds_read_b128 v[20:23], v5 offset:8192
    v_pk_sub_i16 v44, v44, v46
    v_pk_sub_i16 v45, v45, v46
    v_pk_ashrrev_i16 v44, 15, v44 op_sel_hi:[0,1]
    v_mfma_f32_16x16x32_bf16 v[244:247], v[84:87], v[24:27], v[244:247]
    v_pk_ashrrev_i16 v45, 15, v45 op_sel_hi:[0,1]
    v_bfi_b32 v68, v44, 0, v68
    v_bfi_b32 v69, v45, 0, v69
    v_or_b32_e64 v44, v12, v70
    v_mfma_f32_16x16x32_bf16 v[248:251], v[80:83], v[28:31], v[248:251]
    ds_read_b32 v11, v8 offset:96
    ds_read_b128 v[24:27], v5 offset:10240
    v_or_b32_e64 v45, v12, v71
    v_pk_max_u16 v46, v44, v45
    v_pk_min_u16 v47, v44, v45
    v_mfma_f32_16x16x32_bf16 v[252:255], v[84:87], v[28:31], v[252:255]
    v_pk_min_u16 v46, v46, v46 op_sel:[0,1] op_sel_hi:[1,0]
    v_pk_max_u16 v46, v46, v47
    v_pk_max_u16 v46, v46, v46 op_sel:[0,1] op_sel_hi:[1,0]
    v_pk_sub_i16 v44, v44, v46
    v_mfma_f32_16x16x32_bf16 v[192:195], v[88:91], v[32:35], v[192:195]
    ds_read_b128 v[28:31], v5 offset:12288
    v_pk_sub_i16 v45, v45, v46
    v_pk_ashrrev_i16 v44, 15, v44 op_sel_hi:[0,1]
    v_pk_ashrrev_i16 v45, 15, v45 op_sel_hi:[0,1]
    v_mfma_f32_16x16x32_bf16 v[196:199], v[92:95], v[32:35], v[196:199]
    v_bfi_b32 v70, v44, 0, v70
    v_bfi_b32 v71, v45, 0, v71
    v_or_b32 v44, v12, v72
    v_or_b32 v45, v12, v73
    v_mfma_f32_16x16x32_bf16 v[200:203], v[88:91], v[36:39], v[200:203]
    s_waitcnt lgkmcnt(3)
    s_nop 0
    ds_read_b128 v[32:35], v5 offset:14336
    v_pk_max_u16 v46, v44, v45
    v_pk_min_u16 v47, v44, v45
    v_pk_min_u16 v46, v46, v46 op_sel:[0,1] op_sel_hi:[1,0]
    v_pk_max_u16 v46, v46, v47
    v_mfma_f32_16x16x32_bf16 v[204:207], v[92:95], v[36:39], v[204:207]
    v_pk_max_u16 v46, v46, v46 op_sel:[0,1] op_sel_hi:[1,0]
    v_pk_sub_i16 v44, v44, v46
    v_pk_sub_i16 v45, v45, v46
    s_waitcnt lgkmcnt(3)
    v_cmp_ne_u32 vcc, 0, v11
    v_mfma_f32_16x16x32_bf16 v[208:211], v[88:91], v[40:43], v[208:211]
    s_cbranch_vccnz L_spin_C9
L_back_C9:
    s_nop 0
    ds_read_b128 v[36:39], v4 offset:32768
    ds_read_b64_tr_b16 v[80:81], v7 offset:16384
    ds_read_b64_tr_b16 v[82:83], v7 offset:17408
    v_pk_ashrrev_i16 v44, 15, v44 op_sel_hi:[0,1]
    v_mfma_f32_16x16x32_bf16 v[212:215], v[92:95], v[40:43], v[212:215]
    v_pk_ashrrev_i16 v45, 15, v45 op_sel_hi:[0,1]
    v_bfi_b32 v72, v44, 0, v72
    v_bfi_b32 v73, v45, 0, v73
    v_or_b32 v44, v12, v74
    v_or_b32 v45, v12, v75
    v_pk_max_u16 v46, v44, v45
    v_mfma_f32_16x16x32_bf16 v[216:219], v[88:91], v[16:19], v[216:219]
    ds_read_b128 v[40:43], v4 offset:34816
    ds_read_b64_tr_b16 v[84:85], v7 offset:16392
    ds_read_b64_tr_b16 v[86:87], v7 offset:17416
    v_pk_min_u16 v47, v44, v45
    v_pk_min_u16 v46, v46, v46 op_sel:[0,1] op_sel_hi:[1,0]
    v_mfma_f32_16x16x32_bf16 v[220:223], v[92:95], v[16:19], v[220:223]
    v_pk_max_u16 v46, v46, v47
    v_pk_max_u16 v46, v46, v46 op_sel:[0,1] op_sel_hi:[1,0]
    v_pk_sub_i16 v44, v44, v46
    v_pk_sub_i16 v45, v45, v46
    v_pk_ashrrev_i16 v44, 15, v44 op_sel_hi:[0,1]
    v_mfma_f32_16x16x32_bf16 v[224:227], v[88:91], v[20:23], v[224:227]
    s_waitcnt lgkmcnt(6)
    s_nop 0
    ds_read_b128 v[16:19], v4 offset:36864
    v_pk_ashrrev_i16 v45, 15, v45 op_sel_hi:[0,1]
    v_bfi_b32 v74, v44, 0, v74
    v_bfi_b32 v75, v45, 0, v75
    v_mfma_f32_16x16x32_bf16 v[228:231], v[92:95], v[20:23], v[228:231]
    v_or_b32 v44, v12, v76
    v_or_b32 v45, v12, v77
    v_pk_max_u16 v46, v44, v45
    v_pk_min_u16 v47, v44, v45
    v_mfma_f32_16x16x32_bf16 v[232:235], v[88:91], v[24:27], v[232:235]
    ds_read_b128 v[20:23], v4 offset:38912
    v_pk_min_u16 v46, v46, v46 op_sel:[0,1] op_sel_hi:[1,0]
    v_pk_max_u16 v46, v46, v47
    v_pk_max_u16 v46, v46, v46 op_sel:[0,1] op_sel_hi:[1,0]
    v_mfma_f32_16x16x32_bf16 v[236:239], v[92:95], v[24:27], v[236:239]
    v_pk_sub_i16 v44, v44, v46
    v_pk_sub_i16 v45, v45, v46
    v_pk_ashrrev_i16 v44, 15, v44 op_sel_hi:[0,1]
    v_pk_ashrrev_i16 v45, 15, v45 op_sel_hi:[0,1]
    v_mfma_f32_16x16x32_bf16 v[240:243], v[88:91], v[28:31], v[240:243]
    ds_read_b128 v[24:27], v4 offset:40960
    v_bfi_b32 v76, v44, 0, v76
    v_bfi_b32 v77, v45, 0, v77
    v_or_b32_e64 v44, v12, v78
    v_mfma_f32_16x16x32_bf16 v[244:247], v[92:95], v[28:31], v[244:247]
    v_or_b32_e64 v45, v12, v79
    v_pk_max_u16 v46, v44, v45
    v_pk_min_u16 v47, v44, v45
    v_pk_min_u16 v46, v46, v46 op_sel:[0,1] op_sel_hi:[1,0]
    v_mfma_f32_16x16x32_bf16 v[248:251], v[88:91], v[32:35], v[248:251]
    s_waitcnt lgkmcnt(2)
    s_nop 0
    ds_read_b128 v[28:31], v4 offset:43008
    v_pk_max_u16 v46, v46, v47
    v_pk_max_u16 v46, v46, v46 op_sel:[0,1] op_sel_hi:[1,0]
    v_pk_sub_i16 v44, v44, v46
    v_mfma_f32_16x16x32_bf16 v[252:255], v[92:95], v[32:35], v[252:255]
    v_pk_sub_i16 v45, v45, v46
    v_pk_ashrrev_i16 v44, 15, v44 op_sel_hi:[0,1]
    v_pk_ashrrev_i16 v45, 15, v45 op_sel_hi:[0,1]
    v_bfi_b32 v78, v44, 0, v78
    v_mfma_f32_16x16x32_bf16 v[128:131], v[96:99], v[36:39], v[128:131]
    ds_read_b128 v[32:35], v4 offset:45056
    ds_read_b64_tr_b16 v[88:89], v7 offset:24576
    ds_read_b64_tr_b16 v[90:91], v7 offset:25600
    v_bfi_b32 v79, v45, 0, v79
    v_or_b32_e64 v44, v12, v80
    v_mfma_f32_16x16x32_bf16 v[132:135], v[100:103], v[36:39], v[132:135]
    v_or_b32_e64 v45, v12, v81
    v_pk_max_u16 v46, v44, v45
    v_pk_min_u16 v47, v44, v45
    v_pk_min_u16 v46, v46, v46 op_sel:[0,1] op_sel_hi:[1,0]
    v_pk_max_u16 v46, v46, v47
    v_mfma_f32_16x16x32_bf16 v[136:139], v[96:99], v[40:43], v[136:139]
    ds_read_b128 v[36:39], v4 offset:47104
    ds_read_b64_tr_b16 v[92:93], v7 offset:24584
    ds_read_b64_tr_b16 v[94:95], v7 offset:25608
    v_pk_max_u16 v46, v46, v46 op_sel:[0,1] op_sel_hi:[1,0]
    v_pk_sub_i16 v44, v44, v46
    v_mfma_f32_16x16x32_bf16 v[140:143], v[100:103], v[40:43], v[140:143]
    v_pk_sub_i16 v45, v45, v46
    v_pk_ashrrev_i16 v44, 15, v44 op_sel_hi:[0,1]
    v_pk_ashrrev_i16 v45, 15, v45 op_sel_hi:[0,1]
    v_bfi_b32 v80, v44, 0, v80
    v_bfi_b32 v81, v45, 0, v81
    v_mfma_f32_16x16x32_bf16 v[144:147], v[96:99], v[16:19], v[144:147]
    s_waitcnt lgkmcnt(6)
    ds_read_b128 v[40:43], v5 offset:32768
    v_mov_b32 v10, 7
    ds_write_b32 v9, v10
    v_or_b32 v44, v12, v82
    v_or_b32 v45, v12, v83
    v_mfma_f32_16x16x32_bf16 v[148:151], v[100:103], v[16:19], v[148:151]
    v_pk_max_u16 v46, v44, v45
    v_pk_min_u16 v47, v44, v45
    v_pk_min_u16 v46, v46, v46 op_sel:[0,1] op_sel_hi:[1,0]
    v_pk_max_u16 v46, v46, v47
    v_pk_max_u16 v46, v46, v46 op_sel:[0,1] op_sel_hi:[1,0]
    v_mfma_f32_16x16x32_bf16 v[152:155], v[96:99], v[20:23], v[152:155]
    ds_read_b128 v[16:19], v5 offset:34816
    v_pk_sub_i16 v44, v44, v46
    v_pk_sub_i16 v45, v45, v46
    v_pk_ashrrev_i16 v44, 15, v44 op_sel_hi:[0,1]
    v_mfma_f32_16x16x32_bf16 v[156:159], v[100:103], v[20:23], v[156:159]
    v_pk_ashrrev_i16 v45, 15, v45 op_sel_hi:[0,1]
    v_bfi_b32 v82, v44, 0, v82
    v_bfi_b32 v83, v45, 0, v83
    v_or_b32_e64 v44, v12, v84
    v_mfma_f32_16x16x32_bf16 v[160:163], v[96:99], v[24:27], v[160:163]
    ds_read_b128 v[20:23], v5 offset:36864
    v_or_b32_e64 v45, v12, v85
    v_pk_max_u16 v46, v44, v45
    v_pk_min_u16 v47, v44, v45
    v_mfma_f32_16x16x32_bf16 v[164:167], v[100:103], v[24:27], v[164:167]
    v_pk_min_u16 v46, v46, v46 op_sel:[0,1] op_sel_hi:[1,0]
    v_pk_max_u16 v46, v46, v47
    v_pk_max_u16 v46, v46, v46 op_sel:[0,1] op_sel_hi:[1,0]
    v_pk_sub_i16 v44, v44, v46
    v_mfma_f32_16x16x32_bf16 v[168:171], v[96:99], v[28:31], v[168:171]
    s_waitcnt lgkmcnt(3)
    s_nop 0
    ds_read_b128 v[24:27], v5 offset:38912
    v_pk_sub_i16 v45, v45, v46
    v_pk_ashrrev_i16 v44, 15, v44 op_sel_hi:[0,1]
    v_pk_ashrrev_i16 v45, 15, v45 op_sel_hi:[0,1]
    v_mfma_f32_16x16x32_bf16 v[172:175], v[100:103], v[28:31], v[172:175]
    v_bfi_b32 v84, v44, 0, v84
    v_bfi_b32 v85, v45, 0, v85
    v_or_b32 v44, v12, v86
    v_or_b32 v45, v12, v87
    v_mfma_f32_16x16x32_bf16 v[176:179], v[96:99], v[32:35], v[176:179]
    ds_read_b128 v[28:31], v5 offset:40960
    v_pk_max_u16 v46, v44, v45
    v_pk_min_u16 v47, v44, v45
    v_pk_min_u16 v46, v46, v46 op_sel:[0,1] op_sel_hi:[1,0]
    v_mfma_f32_16x16x32_bf16 v[180:183], v[100:103], v[32:35], v[180:183]
    v_pk_max_u16 v46, v46, v47
    v_pk_max_u16 v46, v46, v46 op_sel:[0,1] op_sel_hi:[1,0]
    v_pk_sub_i16 v44, v44, v46
    v_pk_sub_i16 v45, v45, v46
    v_mfma_f32_16x16x32_bf16 v[184:187], v[96:99], v[36:39], v[184:187]
    ds_read_b32 v11, v8 offset:92
    ds_read_b128 v[32:35], v5 offset:43008
    v_pk_ashrrev_i16 v44, 15, v44 op_sel_hi:[0,1]
    v_pk_ashrrev_i16 v45, 15, v45 op_sel_hi:[0,1]
    v_bfi_b32 v86, v44, 0, v86
    v_mfma_f32_16x16x32_bf16 v[188:191], v[100:103], v[36:39], v[188:191]
    v_bfi_b32 v87, v45, 0, v87
    v_or_b32 v44, v12, v88
    v_or_b32 v45, v12, v89
    v_pk_max_u16 v46, v44, v45
    v_mfma_f32_16x16x32_bf16 v[128:131], v[104:107], v[40:43], v[128:131]
    s_waitcnt lgkmcnt(3)
    s_nop 0
    ds_read_b128 v[36:39], v5 offset:45056
    v_pk_min_u16 v47, v44, v45
    v_pk_min_u16 v46, v46, v46 op_sel:[0,1] op_sel_hi:[1,0]
    v_pk_max_u16 v46, v46, v47
    v_mfma_f32_16x16x32_bf16 v[132:135], v[108:111], v[40:43], v[132:135]
    v_pk_max_u16 v46, v46, v46 op_sel:[0,1] op_sel_hi:[1,0]
    v_pk_sub_i16 v44, v44, v46
    v_pk_sub_i16 v45, v45, v46
    v_pk_ashrrev_i16 v44, 15, v44 op_sel_hi:[0,1]
    v_mfma_f32_16x16x32_bf16 v[136:139], v[104:107], v[16:19], v[136:139]
    ds_read_b128 v[40:43], v5 offset:47104
    v_pk_ashrrev_i16 v45, 15, v45 op_sel_hi:[0,1]
    v_bfi_b32 v88, v44, 0, v88
    v_bfi_b32 v89, v45, 0, v89
    v_or_b32_e64 v44, v12, v90
    v_mfma_f32_16x16x32_bf16 v[140:143], v[108:111], v[16:19], v[140:143]
    v_or_b32_e64 v45, v12, v91
    v_pk_max_u16 v46, v44, v45
    v_pk_min_u16 v47, v44, v45
    s_waitcnt lgkmcnt(3)
    v_cmp_ne_u32 vcc, 0, v11
    v_mfma_f32_16x16x32_bf16 v[144:147], v[104:107], v[20:23], v[144:147]
    s_cbranch_vccnz L_spin_C10
L_back_C10:
    ds_read_b128 v[16:19], v2 offset:0
    v_mov_b32 v10, 8
    ds_write_b32 v9, v10
    v_pk_min_u16 v46, v46, v46 op_sel:[0,1] op_sel_hi:[1,0]
    v_mfma_f32_16x16x32_bf16 v[148:151], v[108:111], v[20:23], v[148:151]
    v_pk_max_u16 v46, v46, v47
    v_pk_max_u16 v46, v46, v46 op_sel:[0,1] op_sel_hi:[1,0]
    v_pk_sub_i16 v44, v44, v46
    v_pk_sub_i16 v45, v45, v46
    v_pk_ashrrev_i16 v44, 15, v44 op_sel_hi:[0,1]
    v_pk_ashrrev_i16 v45, 15, v45 op_sel_hi:[0,1]
    v_mfma_f32_16x16x32_bf16 v[152:155], v[104:107], v[24:27], v[152:155]
    s_waitcnt lgkmcnt(3)
    ds_read_b128 v[20:23], v2 offset:2048
    v_bfi_b32 v90, v44, 0, v90
    v_bfi_b32 v91, v45, 0, v91
    v_or_b32 v44, v12, v92
    v_mfma_f32_16x16x32_bf16 v[156:159], v[108:111], v[24:27], v[156:159]
    v_or_b32_e64 v45, v12, v93
    v_pk_max_u16 v46, v44, v45
    v_pk_min_u16 v47, v44, v45
    v_pk_min_u16 v46, v46, v46 op_sel:[0,1] op_sel_hi:[1,0]
    v_mfma_f32_16x16x32_bf16 v[160:163], v[104:107], v[28:31], v[160:163]
    ds_read_b128 v[24:27], v2 offset:4096
    v_pk_max_u16 v46, v46, v47
    v_pk_max_u16 v46, v46, v46 op_sel:[0,1] op_sel_hi:[1,0]
    v_pk_sub_i16 v44, v44, v46
    v_mfma_f32_16x16x32_bf16 v[164:167], v[108:111], v[28:31], v[164:167]
    v_pk_sub_i16 v45, v45, v46
    v_pk_ashrrev_i16 v44, 15, v44 op_sel_hi:[0,1]
    v_pk_ashrrev_i16 v45, 15, v45 op_sel_hi:[0,1]
    v_bfi_b32 v92, v44, 0, v92
    v_mfma_f32_16x16x32_bf16 v[168:171], v[104:107], v[32:35], v[168:171]
    ds_read_b128 v[28:31], v2 offset:6144
    v_bfi_b32 v93, v45, 0, v93
    v_or_b32 v44, v12, v94
    v_or_b32 v45, v12, v95
    v_mfma_f32_16x16x32_bf16 v[172:175], v[108:111], v[32:35], v[172:175]
    v_pk_max_u16 v46, v44, v45
    v_pk_min_u16 v47, v44, v45
    v_pk_min_u16 v46, v46, v46 op_sel:[0,1] op_sel_hi:[1,0]
    v_pk_max_u16 v46, v46, v47
    v_mfma_f32_16x16x32_bf16 v[176:179], v[104:107], v[36:39], v[176:179]
    s_waitcnt lgkmcnt(2)
    s_nop 0
    ds_read_b128 v[32:35], v2 offset:8192
    v_pk_max_u16 v46, v46, v46 op_sel:[0,1] op_sel_hi:[1,0]
    v_pk_sub_i16 v44, v44, v46
    v_pk_sub_i16 v45, v45, v46
    v_mfma_f32_16x16x32_bf16 v[180:183], v[108:111], v[36:39], v[180:183]
    v_pk_ashrrev_i16 v44, 15, v44 op_sel_hi:[0,1]
    v_pk_ashrrev_i16 v45, 15, v45 op_sel_hi:[0,1]
    v_bfi_b32 v94, v44, 0, v94
    v_bfi_b32 v95, v45, 0, v95
    v_mfma_f32_16x16x32_bf16 v[184:187], v[104:107], v[40:43], v[184:187]
    ds_read_b128 v[36:39], v2 offset:10240
    v_mfma_f32_16x16x32_bf16 v[188:191], v[108:111], v[40:43], v[188:191]
    v_mfma_f32_16x16x32_bf16 v[192:195], v[96:99], v[16:19], v[192:195]
    ds_read_b128 v[40:43], v2 offset:12288
    v_and_b32 v44, 15, v1
    v_lshlrev_b32 v44, 10, v44
    v_mfma_f32_16x16x32_bf16 v[196:199], v[100:103], v[16:19], v[196:199]
    v_and_b32 v45, 48, v1
    v_add3_u32 v44, v44, v45, s37
    v_mfma_f32_16x16x32_bf16 v[200:203], v[96:99], v[20:23], v[200:203]
    s_waitcnt lgkmcnt(2)
    v_mfma_f32_16x16x32_bf16 v[204:207], v[100:103], v[20:23], v[204:207]
    ds_read_b128 v[16:19], v2 offset:14336
    v_mfma_f32_16x16x32_bf16 v[208:211], v[96:99], v[24:27], v[208:211]
    ds_read_b128 v[20:23], v3 offset:0
    v_mfma_f32_16x16x32_bf16 v[212:215], v[100:103], v[24:27], v[212:215]
    v_mfma_f32_16x16x32_bf16 v[216:219], v[96:99], v[28:31], v[216:219]
    ds_read_b128 v[24:27], v3 offset:2048
    v_mfma_f32_16x16x32_bf16 v[220:223], v[100:103], v[28:31], v[220:223]
    v_mfma_f32_16x16x32_bf16 v[224:227], v[96:99], v[32:35], v[224:227]
    s_waitcnt lgkmcnt(2)
    v_mfma_f32_16x16x32_bf16 v[228:231], v[100:103], v[32:35], v[228:231]
    ds_read_b128 v[28:31], v3 offset:4096
    v_mfma_f32_16x16x32_bf16 v[232:235], v[96:99], v[36:39], v[232:235]
    ds_read_b128 v[32:35], v3 offset:6144
    v_mfma_f32_16x16x32_bf16 v[236:239], v[100:103], v[36:39], v[236:239]
    v_mfma_f32_16x16x32_bf16 v[240:243], v[96:99], v[40:43], v[240:243]
    ds_read_b128 v[36:39], v3 offset:8192
    v_mfma_f32_16x16x32_bf16 v[244:247], v[100:103], v[40:43], v[244:247]
    v_mfma_f32_16x16x32_bf16 v[248:251], v[96:99], v[16:19], v[248:251]
    s_waitcnt lgkmcnt(2)
    ds_read_b32 v11, v8 offset:88
    ds_read_b128 v[40:43], v3 offset:10240
    v_mfma_f32_16x16x32_bf16 v[252:255], v[100:103], v[16:19], v[252:255]
    v_mfma_f32_16x16x32_bf16 v[192:195], v[104:107], v[20:23], v[192:195]
    ds_read_b128 v[16:19], v3 offset:12288
    v_mfma_f32_16x16x32_bf16 v[196:199], v[108:111], v[20:23], v[196:199]
    v_mfma_f32_16x16x32_bf16 v[200:203], v[104:107], v[24:27], v[200:203]
    ds_read_b128 v[20:23], v3 offset:14336
    s_waitcnt lgkmcnt(3)
    v_mfma_f32_16x16x32_bf16 v[204:207], v[108:111], v[24:27], v[204:207]
    v_cmp_ne_u32 vcc, 0, v11
    v_mfma_f32_16x16x32_bf16 v[208:211], v[104:107], v[28:31], v[208:211]
    s_waitcnt lgkmcnt(2)
    s_cbranch_vccnz L_spin_C11
L_back_C11:
    v_mfma_f32_16x16x32_bf16 v[212:215], v[108:111], v[28:31], v[212:215]
    ds_read_b128 v[24:27], v4 offset:49152
    v_mov_b32_e64 v10, 9
    ds_write_b32 v9, v10
    v_mfma_f32_16x16x32_bf16 v[216:219], v[104:107], v[32:35], v[216:219]
    ds_read_b128 v[28:31], v5 offset:49152
    v_mfma_f32_16x16x32_bf16 v[220:223], v[108:111], v[32:35], v[220:223]
    v_mfma_f32_16x16x32_bf16 v[224:227], v[104:107], v[36:39], v[224:227]
    ds_read_b128 v[32:35], v4 offset:53248
    v_mfma_f32_16x16x32_bf16 v[228:231], v[108:111], v[36:39], v[228:231]
    v_mfma_f32_16x16x32_bf16 v[232:235], v[104:107], v[40:43], v[232:235]
    s_waitcnt lgkmcnt(3)
    v_mfma_f32_16x16x32_bf16 v[236:239], v[108:111], v[40:43], v[236:239]
    ds_read_b128 v[36:39], v5 offset:53248
    v_mfma_f32_16x16x32_bf16 v[240:243], v[104:107], v[16:19], v[240:243]
    ds_read_b128 v[40:43], v4 offset:57344
    v_mfma_f32_16x16x32_bf16 v[244:247], v[108:111], v[16:19], v[244:247]
    v_mfma_f32_16x16x32_bf16 v[248:251], v[104:107], v[20:23], v[248:251]
    ds_read_b128 v[16:19], v5 offset:57344
    v_mfma_f32_16x16x32_bf16 v[252:255], v[108:111], v[20:23], v[252:255]
    v_mfma_f32_16x16x32_bf16 v[128:131], v[112:115], v[24:27], v[128:131]
    s_waitcnt lgkmcnt(2)
    v_mfma_f32_16x16x32_bf16 v[132:135], v[116:119], v[24:27], v[132:135]
    ds_read_b128 v[20:23], v4 offset:61440
    v_mfma_f32_16x16x32_bf16 v[128:131], v[120:123], v[28:31], v[128:131]
    ds_read_b128 v[24:27], v5 offset:61440
    v_mfma_f32_16x16x32_bf16 v[132:135], v[124:127], v[28:31], v[132:135]
    v_mfma_f32_16x16x32_bf16 v[128:131], v[48:51], v[32:35], v[128:131]
    ds_read_b128 v[28:31], v4 offset:51200
    v_mfma_f32_16x16x32_bf16 v[132:135], v[52:55], v[32:35], v[132:135]
    v_mfma_f32_16x16x32_bf16 v[128:131], v[56:59], v[36:39], v[128:131]
    s_waitcnt lgkmcnt(2)
    v_mfma_f32_16x16x32_bf16 v[132:135], v[60:63], v[36:39], v[132:135]
    ds_read_b128 v[32:35], v5 offset:51200
    v_mfma_f32_16x16x32_bf16 v[128:131], v[64:67], v[40:43], v[128:131]
    ds_read_b128 v[36:39], v4 offset:55296
    v_mfma_f32_16x16x32_bf16 v[132:135], v[68:71], v[40:43], v[132:135]
    v_mfma_f32_16x16x32_bf16 v[128:131], v[72:75], v[16:19], v[128:131]
    ds_read_b128 v[40:43], v5 offset:55296
    v_mfma_f32_16x16x32_bf16 v[132:135], v[76:79], v[16:19], v[132:135]
    v_mfma_f32_16x16x32_bf16 v[128:131], v[80:83], v[20:23], v[128:131]
    s_waitcnt lgkmcnt(2)
    v_mfma_f32_16x16x32_bf16 v[132:135], v[84:87], v[20:23], v[132:135]
    ds_read_b128 v[16:19], v4 offset:59392
    v_mfma_f32_16x16x32_bf16 v[128:131], v[88:91], v[24:27], v[128:131]
    ds_read_b32 v11, v8 offset:84
    ds_read_b128 v[20:23], v5 offset:59392
    v_mfma_f32_16x16x32_bf16 v[132:135], v[92:95], v[24:27], v[132:135]
    v_mfma_f32_16x16x32_bf16 v[136:139], v[112:115], v[28:31], v[136:139]
    ds_read_b128 v[24:27], v4 offset:63488
    v_mfma_f32_16x16x32_bf16 v[140:143], v[116:119], v[28:31], v[140:143]
    v_mfma_f32_16x16x32_bf16 v[136:139], v[120:123], v[32:35], v[136:139]
    s_waitcnt lgkmcnt(3)
    ds_read_b128 v[28:31], v5 offset:63488
    v_cvt_pk_bf16_f32 v128, v128, v129
    v_cvt_pk_bf16_f32 v129, v130, v131
    v_mfma_f32_16x16x32_bf16 v[140:143], v[124:127], v[32:35], v[140:143]
    v_cvt_pk_bf16_f32 v130, v132, v133
    s_waitcnt lgkmcnt(3)
    v_cmp_ne_u32 vcc, 0, v11
    v_mfma_f32_16x16x32_bf16 v[136:139], v[48:51], v[36:39], v[136:139]
    s_cbranch_vccnz L_spin_C12
L_back_C12:
    ds_read_b128 v[32:35], v2 offset:16384
    v_cvt_pk_bf16_f32 v131, v134, v135
    v_mfma_f32_16x16x32_bf16 v[140:143], v[52:55], v[36:39], v[140:143]
    s_xor_b32 s39, s38, 0x0
    buffer_store_dwordx4 v[128:131], v44, s[20:23], s39 offen sc0 sc1 nt
    v_mfma_f32_16x16x32_bf16 v[136:139], v[56:59], v[40:43], v[136:139]
    ds_read_b128 v[36:39], v3 offset:16384
    v_mfma_f32_16x16x32_bf16 v[140:143], v[60:63], v[40:43], v[140:143]
    v_mfma_f32_16x16x32_bf16 v[136:139], v[64:67], v[16:19], v[136:139]
    s_waitcnt lgkmcnt(2)
    v_mfma_f32_16x16x32_bf16 v[140:143], v[68:71], v[16:19], v[140:143]
    ds_read_b128 v[40:43], v2 offset:20480
    v_mfma_f32_16x16x32_bf16 v[136:139], v[72:75], v[20:23], v[136:139]
    ds_read_b128 v[16:19], v3 offset:20480
    v_mfma_f32_16x16x32_bf16 v[140:143], v[76:79], v[20:23], v[140:143]
    v_mfma_f32_16x16x32_bf16 v[136:139], v[80:83], v[24:27], v[136:139]
    ds_read_b128 v[20:23], v2 offset:24576
    v_mfma_f32_16x16x32_bf16 v[140:143], v[84:87], v[24:27], v[140:143]
    v_mfma_f32_16x16x32_bf16 v[136:139], v[88:91], v[28:31], v[136:139]
    s_waitcnt lgkmcnt(2)
    v_mfma_f32_16x16x32_bf16 v[140:143], v[92:95], v[28:31], v[140:143]
    ds_read_b128 v[24:27], v3 offset:24576
    v_mfma_f32_16x16x32_bf16 v[144:147], v[112:115], v[32:35], v[144:147]
    ds_read_b128 v[28:31], v2 offset:28672
    v_mfma_f32_16x16x32_bf16 v[148:151], v[116:119], v[32:35], v[148:151]
    v_mfma_f32_16x16x32_bf16 v[144:147], v[120:123], v[36:39], v[144:147]
    ds_read_b128 v[32:35], v3 offset:28672
    v_cvt_pk_bf16_f32 v132, v136, v137
    v_mfma_f32_16x16x32_bf16 v[148:151], v[124:127], v[36:39], v[148:151]
    v_cvt_pk_bf16_f32 v133, v138, v139
    v_cvt_pk_bf16_f32 v134, v140, v141
    v_mfma_f32_16x16x32_bf16 v[144:147], v[48:51], v[40:43], v[144:147]
    s_waitcnt lgkmcnt(2)
    ds_read_b128 v[36:39], v2 offset:18432
    v_cvt_pk_bf16_f32 v135, v142, v143
    v_mfma_f32_16x16x32_bf16 v[148:151], v[52:55], v[40:43], v[148:151]
    s_xor_b32 s39, s38, 0x4000
    buffer_store_dwordx4 v[132:135], v44, s[20:23], s39 offen sc0 sc1 nt
    v_mfma_f32_16x16x32_bf16 v[144:147], v[56:59], v[16:19], v[144:147]
    ds_read_b128 v[40:43], v3 offset:18432
    v_mfma_f32_16x16x32_bf16 v[148:151], v[60:63], v[16:19], v[148:151]
    v_mfma_f32_16x16x32_bf16 v[144:147], v[64:67], v[20:23], v[144:147]
    ds_read_b128 v[16:19], v2 offset:22528
    v_mfma_f32_16x16x32_bf16 v[148:151], v[68:71], v[20:23], v[148:151]
    v_mfma_f32_16x16x32_bf16 v[144:147], v[72:75], v[24:27], v[144:147]
    s_waitcnt lgkmcnt(2)
    v_mfma_f32_16x16x32_bf16 v[148:151], v[76:79], v[24:27], v[148:151]
    ds_read_b128 v[20:23], v3 offset:22528
    v_mfma_f32_16x16x32_bf16 v[144:147], v[80:83], v[28:31], v[144:147]
    ds_read_b128 v[24:27], v2 offset:26624
    v_mfma_f32_16x16x32_bf16 v[148:151], v[84:87], v[28:31], v[148:151]
    v_mfma_f32_16x16x32_bf16 v[144:147], v[88:91], v[32:35], v[144:147]
    ds_read_b32 v11, v8 offset:80
    ds_read_b128 v[28:31], v3 offset:26624
    v_mfma_f32_16x16x32_bf16 v[148:151], v[92:95], v[32:35], v[148:151]
    v_mfma_f32_16x16x32_bf16 v[152:155], v[112:115], v[36:39], v[152:155]
    s_waitcnt lgkmcnt(3)
    v_mfma_f32_16x16x32_bf16 v[156:159], v[116:119], v[36:39], v[156:159]
    ds_read_b128 v[32:35], v2 offset:30720
    v_mfma_f32_16x16x32_bf16 v[152:155], v[120:123], v[40:43], v[152:155]
    ds_read_b128 v[36:39], v3 offset:30720
    v_cvt_pk_bf16_f32 v144, v144, v145
    v_cvt_pk_bf16_f32 v145, v146, v147
    v_mfma_f32_16x16x32_bf16 v[156:159], v[124:127], v[40:43], v[156:159]
    v_cvt_pk_bf16_f32 v146, v148, v149
    s_waitcnt lgkmcnt(3)
    v_cmp_ne_u32 vcc, 0, v11
    v_mfma_f32_16x16x32_bf16 v[152:155], v[48:51], v[16:19], v[152:155]
    s_cbranch_vccnz L_spin_C13
L_back_C13:
    ds_read_b128 v[40:43], v2 offset:32768
    v_cvt_pk_bf16_f32 v147, v150, v151
    v_mfma_f32_16x16x32_bf16 v[156:159], v[52:55], v[16:19], v[156:159]
    s_xor_b32 s39, s38, 0x8000
    buffer_store_dwordx4 v[144:147], v44, s[20:23], s39 offen sc0 sc1 nt
    v_mfma_f32_16x16x32_bf16 v[152:155], v[56:59], v[20:23], v[152:155]
    s_waitcnt lgkmcnt(2)
    v_mfma_f32_16x16x32_bf16 v[156:159], v[60:63], v[20:23], v[156:159]
    ds_read_b128 v[16:19], v3 offset:32768
    v_mfma_f32_16x16x32_bf16 v[152:155], v[64:67], v[24:27], v[152:155]
    ds_read_b128 v[20:23], v2 offset:36864
    v_mfma_f32_16x16x32_bf16 v[156:159], v[68:71], v[24:27], v[156:159]
    v_mfma_f32_16x16x32_bf16 v[152:155], v[72:75], v[28:31], v[152:155]
    ds_read_b128 v[24:27], v3 offset:36864
    v_mfma_f32_16x16x32_bf16 v[156:159], v[76:79], v[28:31], v[156:159]
    v_mfma_f32_16x16x32_bf16 v[152:155], v[80:83], v[32:35], v[152:155]
    s_waitcnt lgkmcnt(2)
    v_mfma_f32_16x16x32_bf16 v[156:159], v[84:87], v[32:35], v[156:159]
    ds_read_b128 v[28:31], v2 offset:40960
    v_mfma_f32_16x16x32_bf16 v[152:155], v[88:91], v[36:39], v[152:155]
    ds_read_b128 v[32:35], v3 offset:40960
    v_mfma_f32_16x16x32_bf16 v[156:159], v[92:95], v[36:39], v[156:159]
    v_mfma_f32_16x16x32_bf16 v[160:163], v[112:115], v[40:43], v[160:163]
    ds_read_b128 v[36:39], v2 offset:45056
    v_mfma_f32_16x16x32_bf16 v[164:167], v[116:119], v[40:43], v[164:167]
    v_mfma_f32_16x16x32_bf16 v[160:163], v[120:123], v[16:19], v[160:163]
    s_waitcnt lgkmcnt(2)
    ds_read_b128 v[40:43], v3 offset:45056
    v_cvt_pk_bf16_f32 v148, v152, v153
    v_mfma_f32_16x16x32_bf16 v[164:167], v[124:127], v[16:19], v[164:167]
    v_cvt_pk_bf16_f32 v149, v154, v155
    v_cvt_pk_bf16_f32 v150, v156, v157
    v_mfma_f32_16x16x32_bf16 v[160:163], v[48:51], v[20:23], v[160:163]
    ds_read_b128 v[16:19], v2 offset:34816
    v_cvt_pk_bf16_f32 v151, v158, v159
    v_mfma_f32_16x16x32_bf16 v[164:167], v[52:55], v[20:23], v[164:167]
    s_xor_b32 s39, s38, 0xc000
    buffer_store_dwordx4 v[148:151], v44, s[20:23], s39 offen sc0 sc1 nt
    v_mfma_f32_16x16x32_bf16 v[160:163], v[56:59], v[24:27], v[160:163]
    ds_read_b128 v[20:23], v3 offset:34816
    v_mfma_f32_16x16x32_bf16 v[164:167], v[60:63], v[24:27], v[164:167]
    v_mfma_f32_16x16x32_bf16 v[160:163], v[64:67], v[28:31], v[160:163]
    s_waitcnt lgkmcnt(2)
    v_mfma_f32_16x16x32_bf16 v[164:167], v[68:71], v[28:31], v[164:167]
    ds_read_b128 v[24:27], v2 offset:38912
    v_mfma_f32_16x16x32_bf16 v[160:163], v[72:75], v[32:35], v[160:163]
    ds_read_b128 v[28:31], v3 offset:38912
    v_mfma_f32_16x16x32_bf16 v[164:167], v[76:79], v[32:35], v[164:167]
    v_mfma_f32_16x16x32_bf16 v[160:163], v[80:83], v[36:39], v[160:163]
    ds_read_b128 v[32:35], v2 offset:43008
    v_mfma_f32_16x16x32_bf16 v[164:167], v[84:87], v[36:39], v[164:167]
    v_mfma_f32_16x16x32_bf16 v[160:163], v[88:91], v[40:43], v[160:163]
    s_waitcnt lgkmcnt(2)
    ds_read_b32 v11, v8 offset:76
    ds_read_b128 v[36:39], v3 offset:43008
    v_mfma_f32_16x16x32_bf16 v[164:167], v[92:95], v[40:43], v[164:167]
    v_mfma_f32_16x16x32_bf16 v[168:171], v[112:115], v[16:19], v[168:171]
    ds_read_b128 v[40:43], v2 offset:47104
    v_mfma_f32_16x16x32_bf16 v[172:175], v[116:119], v[16:19], v[172:175]
    v_mfma_f32_16x16x32_bf16 v[168:171], v[120:123], v[20:23], v[168:171]
    ds_read_b128 v[16:19], v3 offset:47104
    v_cvt_pk_bf16_f32 v160, v160, v161
    v_cvt_pk_bf16_f32 v161, v162, v163
    v_mfma_f32_16x16x32_bf16 v[172:175], v[124:127], v[20:23], v[172:175]
    v_cvt_pk_bf16_f32 v162, v164, v165
    s_waitcnt lgkmcnt(3)
    v_cmp_ne_u32 vcc, 0, v11
    v_mfma_f32_16x16x32_bf16 v[168:171], v[48:51], v[24:27], v[168:171]
    s_waitcnt lgkmcnt(2)
    s_cbranch_vccnz L_spin_C14
L_back_C14:
    ds_read_b128 v[20:23], v2 offset:49152
    v_cvt_pk_bf16_f32 v163, v166, v167
    v_mfma_f32_16x16x32_bf16 v[172:175], v[52:55], v[24:27], v[172:175]
    s_xor_b32 s39, s38, 0x10000
    buffer_store_dwordx4 v[160:163], v44, s[20:23], s39 offen sc0 sc1 nt
    v_mfma_f32_16x16x32_bf16 v[168:171], v[56:59], v[28:31], v[168:171]
    ds_read_b128 v[24:27], v3 offset:49152
    v_mfma_f32_16x16x32_bf16 v[172:175], v[60:63], v[28:31], v[172:175]
    v_mfma_f32_16x16x32_bf16 v[168:171], v[64:67], v[32:35], v[168:171]
    ds_read_b128 v[28:31], v2 offset:53248
    v_mfma_f32_16x16x32_bf16 v[172:175], v[68:71], v[32:35], v[172:175]
    v_mfma_f32_16x16x32_bf16 v[168:171], v[72:75], v[36:39], v[168:171]
    s_waitcnt lgkmcnt(2)
    v_mfma_f32_16x16x32_bf16 v[172:175], v[76:79], v[36:39], v[172:175]
    ds_read_b128 v[32:35], v3 offset:53248
    v_mfma_f32_16x16x32_bf16 v[168:171], v[80:83], v[40:43], v[168:171]
    ds_read_b128 v[36:39], v2 offset:57344
    v_mfma_f32_16x16x32_bf16 v[172:175], v[84:87], v[40:43], v[172:175]
    v_mfma_f32_16x16x32_bf16 v[168:171], v[88:91], v[16:19], v[168:171]
    ds_read_b128 v[40:43], v3 offset:57344
    v_mfma_f32_16x16x32_bf16 v[172:175], v[92:95], v[16:19], v[172:175]
    v_mfma_f32_16x16x32_bf16 v[176:179], v[112:115], v[20:23], v[176:179]
    s_waitcnt lgkmcnt(2)
    v_mfma_f32_16x16x32_bf16 v[180:183], v[116:119], v[20:23], v[180:183]
    ds_read_b128 v[16:19], v2 offset:61440
    v_mfma_f32_16x16x32_bf16 v[176:179], v[120:123], v[24:27], v[176:179]
    ds_read_b128 v[20:23], v3 offset:61440
    v_cvt_pk_bf16_f32 v164, v168, v169
    v_mfma_f32_16x16x32_bf16 v[180:183], v[124:127], v[24:27], v[180:183]
    v_cvt_pk_bf16_f32 v165, v170, v171
    v_cvt_pk_bf16_f32 v166, v172, v173
    v_mfma_f32_16x16x32_bf16 v[176:179], v[48:51], v[28:31], v[176:179]
    ds_read_b128 v[24:27], v2 offset:51200
    v_cvt_pk_bf16_f32 v167, v174, v175
    v_mfma_f32_16x16x32_bf16 v[180:183], v[52:55], v[28:31], v[180:183]
    s_xor_b32 s39, s38, 0x14000
    buffer_store_dwordx4 v[164:167], v44, s[20:23], s39 offen sc0 sc1 nt
    v_mfma_f32_16x16x32_bf16 v[176:179], v[56:59], v[32:35], v[176:179]
    s_waitcnt lgkmcnt(2)
    v_mfma_f32_16x16x32_bf16 v[180:183], v[60:63], v[32:35], v[180:183]
    ds_read_b128 v[28:31], v3 offset:51200
    v_mfma_f32_16x16x32_bf16 v[176:179], v[64:67], v[36:39], v[176:179]
    ds_read_b128 v[32:35], v2 offset:55296
    v_mfma_f32_16x16x32_bf16 v[180:183], v[68:71], v[36:39], v[180:183]
    v_mfma_f32_16x16x32_bf16 v[176:179], v[72:75], v[40:43], v[176:179]
    ds_read_b128 v[36:39], v3 offset:55296
    v_mfma_f32_16x16x32_bf16 v[180:183], v[76:79], v[40:43], v[180:183]
    v_mfma_f32_16x16x32_bf16 v[176:179], v[80:83], v[16:19], v[176:179]
    s_waitcnt lgkmcnt(2)
    v_mfma_f32_16x16x32_bf16 v[180:183], v[84:87], v[16:19], v[180:183]
    ds_read_b128 v[40:43], v2 offset:59392
    v_mfma_f32_16x16x32_bf16 v[176:179], v[88:91], v[20:23], v[176:179]
    ds_read_b32 v11, v8 offset:72
    ds_read_b128 v[16:19], v3 offset:59392
    v_mfma_f32_16x16x32_bf16 v[180:183], v[92:95], v[20:23], v[180:183]
    v_mfma_f32_16x16x32_bf16 v[184:187], v[112:115], v[24:27], v[184:187]
    ds_read_b128 v[20:23], v2 offset:63488
    v_mfma_f32_16x16x32_bf16 v[188:191], v[116:119], v[24:27], v[188:191]
    v_mfma_f32_16x16x32_bf16 v[184:187], v[120:123], v[28:31], v[184:187]
    s_waitcnt lgkmcnt(3)
    ds_read_b128 v[24:27], v3 offset:63488
    v_cvt_pk_bf16_f32 v176, v176, v177
    v_cvt_pk_bf16_f32 v177, v178, v179
    v_mfma_f32_16x16x32_bf16 v[188:191], v[124:127], v[28:31], v[188:191]
    v_cvt_pk_bf16_f32 v178, v180, v181
    s_waitcnt lgkmcnt(3)
    v_cmp_ne_u32 vcc, 0, v11
    v_mfma_f32_16x16x32_bf16 v[184:187], v[48:51], v[32:35], v[184:187]
    s_cbranch_vccnz L_spin_C15
L_back_C15:
    ds_read_b128 v[28:31], v4 offset:0
    v_cvt_pk_bf16_f32 v179, v182, v183
    v_mfma_f32_16x16x32_bf16 v[188:191], v[52:55], v[32:35], v[188:191]
    s_xor_b32 s39, s38, 0x18000
    buffer_store_dwordx4 v[176:179], v44, s[20:23], s39 offen sc0 sc1 nt
    v_mfma_f32_16x16x32_bf16 v[184:187], v[56:59], v[36:39], v[184:187]
    ds_read_b128 v[32:35], v5 offset:0
    v_mfma_f32_16x16x32_bf16 v[188:191], v[60:63], v[36:39], v[188:191]
    v_mfma_f32_16x16x32_bf16 v[184:187], v[64:67], v[40:43], v[184:187]
    s_waitcnt lgkmcnt(2)
    v_mfma_f32_16x16x32_bf16 v[188:191], v[68:71], v[40:43], v[188:191]
    ds_read_b128 v[36:39], v4 offset:4096
    v_mfma_f32_16x16x32_bf16 v[184:187], v[72:75], v[16:19], v[184:187]
    ds_read_b128 v[40:43], v5 offset:4096
    v_mfma_f32_16x16x32_bf16 v[188:191], v[76:79], v[16:19], v[188:191]
    v_mfma_f32_16x16x32_bf16 v[184:187], v[80:83], v[20:23], v[184:187]
    ds_read_b128 v[16:19], v4 offset:8192
    v_mfma_f32_16x16x32_bf16 v[188:191], v[84:87], v[20:23], v[188:191]
    v_mfma_f32_16x16x32_bf16 v[184:187], v[88:91], v[24:27], v[184:187]
    s_waitcnt lgkmcnt(2)
    v_mfma_f32_16x16x32_bf16 v[188:191], v[92:95], v[24:27], v[188:191]
    ds_read_b128 v[20:23], v5 offset:8192
    v_mfma_f32_16x16x32_bf16 v[192:195], v[112:115], v[28:31], v[192:195]
    ds_read_b128 v[24:27], v4 offset:12288
    v_mfma_f32_16x16x32_bf16 v[196:199], v[116:119], v[28:31], v[196:199]
    v_mfma_f32_16x16x32_bf16 v[192:195], v[120:123], v[32:35], v[192:195]
    ds_read_b128 v[28:31], v5 offset:12288
    v_cvt_pk_bf16_f32 v180, v184, v185
    v_mfma_f32_16x16x32_bf16 v[196:199], v[124:127], v[32:35], v[196:199]
    v_cvt_pk_bf16_f32 v181, v186, v187
    v_cvt_pk_bf16_f32 v182, v188, v189
    v_mfma_f32_16x16x32_bf16 v[192:195], v[48:51], v[36:39], v[192:195]
    s_waitcnt lgkmcnt(2)
    ds_read_b128 v[32:35], v4 offset:2048
    v_cvt_pk_bf16_f32 v183, v190, v191
    v_mfma_f32_16x16x32_bf16 v[196:199], v[52:55], v[36:39], v[196:199]
    s_xor_b32 s39, s38, 0x1c000
    buffer_store_dwordx4 v[180:183], v44, s[20:23], s39 offen sc0 sc1 nt
    v_mfma_f32_16x16x32_bf16 v[192:195], v[56:59], v[40:43], v[192:195]
    ds_read_b128 v[36:39], v5 offset:2048
    v_mfma_f32_16x16x32_bf16 v[196:199], v[60:63], v[40:43], v[196:199]
    v_mfma_f32_16x16x32_bf16 v[192:195], v[64:67], v[16:19], v[192:195]
    ds_read_b128 v[40:43], v4 offset:6144
    v_mfma_f32_16x16x32_bf16 v[196:199], v[68:71], v[16:19], v[196:199]
    v_mfma_f32_16x16x32_bf16 v[192:195], v[72:75], v[20:23], v[192:195]
    s_waitcnt lgkmcnt(2)
    v_mfma_f32_16x16x32_bf16 v[196:199], v[76:79], v[20:23], v[196:199]
    ds_read_b128 v[16:19], v5 offset:6144
    v_mfma_f32_16x16x32_bf16 v[192:195], v[80:83], v[24:27], v[192:195]
    ds_read_b128 v[20:23], v4 offset:10240
    v_mfma_f32_16x16x32_bf16 v[196:199], v[84:87], v[24:27], v[196:199]
    v_mfma_f32_16x16x32_bf16 v[192:195], v[88:91], v[28:31], v[192:195]
    ds_read_b32 v11, v8 offset:68
    ds_read_b128 v[24:27], v5 offset:10240
    v_mfma_f32_16x16x32_bf16 v[196:199], v[92:95], v[28:31], v[196:199]
    v_mfma_f32_16x16x32_bf16 v[200:203], v[112:115], v[32:35], v[200:203]
    s_waitcnt lgkmcnt(3)
    v_mfma_f32_16x16x32_bf16 v[204:207], v[116:119], v[32:35], v[204:207]
    ds_read_b128 v[28:31], v4 offset:14336
    v_mfma_f32_16x16x32_bf16 v[200:203], v[120:123], v[36:39], v[200:203]
    ds_read_b128 v[32:35], v5 offset:14336
    v_cvt_pk_bf16_f32 v192, v192, v193
    v_cvt_pk_bf16_f32 v193, v194, v195
    v_mfma_f32_16x16x32_bf16 v[204:207], v[124:127], v[36:39], v[204:207]
    v_cvt_pk_bf16_f32 v194, v196, v197
    s_waitcnt lgkmcnt(3)
    v_cmp_ne_u32 vcc, 0, v11
    v_mfma_f32_16x16x32_bf16 v[200:203], v[48:51], v[40:43], v[200:203]
    s_cbranch_vccnz L_spin_C16
L_back_C16:
    ds_read_b128 v[36:39], v4 offset:16384
    v_cvt_pk_bf16_f32 v195, v198, v199
    v_mfma_f32_16x16x32_bf16 v[204:207], v[52:55], v[40:43], v[204:207]
    s_xor_b32 s39, s38, 0x20000
    buffer_store_dwordx4 v[192:195], v44, s[20:23], s39 offen sc0 sc1 nt
    v_mfma_f32_16x16x32_bf16 v[200:203], v[56:59], v[16:19], v[200:203]
    s_waitcnt lgkmcnt(2)
    v_mfma_f32_16x16x32_bf16 v[204:207], v[60:63], v[16:19], v[204:207]
    ds_read_b128 v[40:43], v5 offset:16384
    v_mfma_f32_16x16x32_bf16 v[200:203], v[64:67], v[20:23], v[200:203]
    ds_read_b128 v[16:19], v4 offset:20480
    v_mfma_f32_16x16x32_bf16 v[204:207], v[68:71], v[20:23], v[204:207]
    v_mfma_f32_16x16x32_bf16 v[200:203], v[72:75], v[24:27], v[200:203]
    ds_read_b128 v[20:23], v5 offset:20480
    v_mfma_f32_16x16x32_bf16 v[204:207], v[76:79], v[24:27], v[204:207]
    v_mfma_f32_16x16x32_bf16 v[200:203], v[80:83], v[28:31], v[200:203]
    s_waitcnt lgkmcnt(2)
    v_mfma_f32_16x16x32_bf16 v[204:207], v[84:87], v[28:31], v[204:207]
    ds_read_b128 v[24:27], v4 offset:24576
    v_mfma_f32_16x16x32_bf16 v[200:203], v[88:91], v[32:35], v[200:203]
    ds_read_b128 v[28:31], v5 offset:24576
    v_mfma_f32_16x16x32_bf16 v[204:207], v[92:95], v[32:35], v[204:207]
    v_mfma_f32_16x16x32_bf16 v[208:211], v[112:115], v[36:39], v[208:211]
    ds_read_b128 v[32:35], v4 offset:28672
    v_mfma_f32_16x16x32_bf16 v[212:215], v[116:119], v[36:39], v[212:215]
    v_mfma_f32_16x16x32_bf16 v[208:211], v[120:123], v[40:43], v[208:211]
    s_waitcnt lgkmcnt(2)
    ds_read_b128 v[36:39], v5 offset:28672
    v_cvt_pk_bf16_f32 v196, v200, v201
    v_mfma_f32_16x16x32_bf16 v[212:215], v[124:127], v[40:43], v[212:215]
    v_cvt_pk_bf16_f32 v197, v202, v203
    v_cvt_pk_bf16_f32 v198, v204, v205
    v_mfma_f32_16x16x32_bf16 v[208:211], v[48:51], v[16:19], v[208:211]
    ds_read_b128 v[40:43], v4 offset:18432
    v_cvt_pk_bf16_f32 v199, v206, v207
    v_mfma_f32_16x16x32_bf16 v[212:215], v[52:55], v[16:19], v[212:215]
    s_xor_b32 s39, s38, 0x24000
    buffer_store_dwordx4 v[196:199], v44, s[20:23], s39 offen sc0 sc1 nt
    v_mfma_f32_16x16x32_bf16 v[208:211], v[56:59], v[20:23], v[208:211]
    ds_read_b128 v[16:19], v5 offset:18432
    v_mfma_f32_16x16x32_bf16 v[212:215], v[60:63], v[20:23], v[212:215]
    v_mfma_f32_16x16x32_bf16 v[208:211], v[64:67], v[24:27], v[208:211]
    s_waitcnt lgkmcnt(2)
    v_mfma_f32_16x16x32_bf16 v[212:215], v[68:71], v[24:27], v[212:215]
    ds_read_b128 v[20:23], v4 offset:22528
    v_mfma_f32_16x16x32_bf16 v[208:211], v[72:75], v[28:31], v[208:211]
    ds_read_b128 v[24:27], v5 offset:22528
    v_mfma_f32_16x16x32_bf16 v[212:215], v[76:79], v[28:31], v[212:215]
    v_mfma_f32_16x16x32_bf16 v[208:211], v[80:83], v[32:35], v[208:211]
    ds_read_b128 v[28:31], v4 offset:26624
    v_mfma_f32_16x16x32_bf16 v[212:215], v[84:87], v[32:35], v[212:215]
    v_mfma_f32_16x16x32_bf16 v[208:211], v[88:91], v[36:39], v[208:211]
    s_waitcnt lgkmcnt(2)
    ds_read_b32 v11, v8 offset:64
    ds_read_b128 v[32:35], v5 offset:26624
    v_mfma_f32_16x16x32_bf16 v[212:215], v[92:95], v[36:39], v[212:215]
    v_mfma_f32_16x16x32_bf16 v[216:219], v[112:115], v[40:43], v[216:219]
    ds_read_b128 v[36:39], v4 offset:30720
    v_mfma_f32_16x16x32_bf16 v[220:223], v[116:119], v[40:43], v[220:223]
    v_mfma_f32_16x16x32_bf16 v[216:219], v[120:123], v[16:19], v[216:219]
    ds_read_b128 v[40:43], v5 offset:30720
    v_cvt_pk_bf16_f32 v208, v208, v209
    v_cvt_pk_bf16_f32 v209, v210, v211
    v_mfma_f32_16x16x32_bf16 v[220:223], v[124:127], v[16:19], v[220:223]
    v_cvt_pk_bf16_f32 v210, v212, v213
    s_waitcnt lgkmcnt(3)
    v_cmp_ne_u32 vcc, 0, v11
    v_mfma_f32_16x16x32_bf16 v[216:219], v[48:51], v[20:23], v[216:219]
    s_waitcnt lgkmcnt(2)
    s_cbranch_vccnz L_spin_C17
L_back_C17:
    ds_read_b128 v[16:19], v4 offset:32768
    v_cvt_pk_bf16_f32 v211, v214, v215
    v_mfma_f32_16x16x32_bf16 v[220:223], v[52:55], v[20:23], v[220:223]
    s_xor_b32 s39, s38, 0x28000
    buffer_store_dwordx4 v[208:211], v44, s[20:23], s39 offen sc0 sc1 nt
    v_mfma_f32_16x16x32_bf16 v[216:219], v[56:59], v[24:27], v[216:219]
    ds_read_b128 v[20:23], v5 offset:32768
    v_mfma_f32_16x16x32_bf16 v[220:223], v[60:63], v[24:27], v[220:223]
    v_mfma_f32_16x16x32_bf16 v[216:219], v[64:67], v[28:31], v[216:219]
    ds_read_b128 v[24:27], v4 offset:36864
    v_mfma_f32_16x16x32_bf16 v[220:223], v[68:71], v[28:31], v[220:223]
    v_mfma_f32_16x16x32_bf16 v[216:219], v[72:75], v[32:35], v[216:219]
    s_waitcnt lgkmcnt(2)
    v_mfma_f32_16x16x32_bf16 v[220:223], v[76:79], v[32:35], v[220:223]
    ds_read_b128 v[28:31], v5 offset:36864
    v_mfma_f32_16x16x32_bf16 v[216:219], v[80:83], v[36:39], v[216:219]
    ds_read_b128 v[32:35], v4 offset:40960
    v_mfma_f32_16x16x32_bf16 v[220:223], v[84:87], v[36:39], v[220:223]
    v_mfma_f32_16x16x32_bf16 v[216:219], v[88:91], v[40:43], v[216:219]
    ds_read_b128 v[36:39], v5 offset:40960
    v_mfma_f32_16x16x32_bf16 v[220:223], v[92:95], v[40:43], v[220:223]
    v_mfma_f32_16x16x32_bf16 v[224:227], v[112:115], v[16:19], v[224:227]
    s_waitcnt lgkmcnt(2)
    v_mfma_f32_16x16x32_bf16 v[228:231], v[116:119], v[16:19], v[228:231]
    ds_read_b128 v[40:43], v4 offset:45056
    v_mfma_f32_16x16x32_bf16 v[224:227], v[120:123], v[20:23], v[224:227]
    ds_read_b128 v[16:19], v5 offset:45056
    v_cvt_pk_bf16_f32 v212, v216, v217
    v_mfma_f32_16x16x32_bf16 v[228:231], v[124:127], v[20:23], v[228:231]
    v_cvt_pk_bf16_f32 v213, v218, v219
    v_cvt_pk_bf16_f32 v214, v220, v221
    v_mfma_f32_16x16x32_bf16 v[224:227], v[48:51], v[24:27], v[224:227]
    ds_read_b128 v[20:23], v4 offset:34816
    v_cvt_pk_bf16_f32 v215, v222, v223
    v_mfma_f32_16x16x32_bf16 v[228:231], v[52:55], v[24:27], v[228:231]
    s_xor_b32 s39, s38, 0x2c000
    buffer_store_dwordx4 v[212:215], v44, s[20:23], s39 offen sc0 sc1 nt
    v_mfma_f32_16x16x32_bf16 v[224:227], v[56:59], v[28:31], v[224:227]
    s_waitcnt lgkmcnt(2)
    v_mfma_f32_16x16x32_bf16 v[228:231], v[60:63], v[28:31], v[228:231]
    ds_read_b128 v[24:27], v5 offset:34816
    v_mfma_f32_16x16x32_bf16 v[224:227], v[64:67], v[32:35], v[224:227]
    ds_read_b128 v[28:31], v4 offset:38912
    v_mfma_f32_16x16x32_bf16 v[228:231], v[68:71], v[32:35], v[228:231]
    v_mfma_f32_16x16x32_bf16 v[224:227], v[72:75], v[36:39], v[224:227]
    ds_read_b128 v[32:35], v5 offset:38912
    v_mfma_f32_16x16x32_bf16 v[228:231], v[76:79], v[36:39], v[228:231]
    v_mfma_f32_16x16x32_bf16 v[224:227], v[80:83], v[40:43], v[224:227]
    s_waitcnt lgkmcnt(2)
    v_mfma_f32_16x16x32_bf16 v[228:231], v[84:87], v[40:43], v[228:231]
    ds_read_b128 v[36:39], v4 offset:43008
    v_mfma_f32_16x16x32_bf16 v[224:227], v[88:91], v[16:19], v[224:227]
    ds_read_b32 v11, v8 offset:60
    ds_read_b128 v[40:43], v5 offset:43008
    v_mfma_f32_16x16x32_bf16 v[228:231], v[92:95], v[16:19], v[228:231]
    v_mfma_f32_16x16x32_bf16 v[232:235], v[112:115], v[20:23], v[232:235]
    ds_read_b128 v[16:19], v4 offset:47104
    v_mfma_f32_16x16x32_bf16 v[236:239], v[116:119], v[20:23], v[236:239]
    v_mfma_f32_16x16x32_bf16 v[232:235], v[120:123], v[24:27], v[232:235]
    s_waitcnt lgkmcnt(3)
    ds_read_b128 v[20:23], v5 offset:47104
    v_cvt_pk_bf16_f32 v224, v224, v225
    v_cvt_pk_bf16_f32 v225, v226, v227
    v_mfma_f32_16x16x32_bf16 v[236:239], v[124:127], v[24:27], v[236:239]
    v_cvt_pk_bf16_f32 v226, v228, v229
    s_waitcnt lgkmcnt(3)
    v_cmp_ne_u32 vcc, 0, v11
    v_mfma_f32_16x16x32_bf16 v[232:235], v[48:51], v[28:31], v[232:235]
    s_cbranch_vccnz L_spin_C18
L_back_C18:
    ds_read_b128 v[24:27], v2 offset:0
    v_cvt_pk_bf16_f32 v227, v230, v231
    v_mfma_f32_16x16x32_bf16 v[236:239], v[52:55], v[28:31], v[236:239]
    s_xor_b32 s39, s38, 0x30000
    buffer_store_dwordx4 v[224:227], v44, s[20:23], s39 offen sc0 sc1 nt
    v_mfma_f32_16x16x32_bf16 v[232:235], v[56:59], v[32:35], v[232:235]
    ds_read_b128 v[28:31], v3 offset:0
    v_mfma_f32_16x16x32_bf16 v[236:239], v[60:63], v[32:35], v[236:239]
    v_mfma_f32_16x16x32_bf16 v[232:235], v[64:67], v[36:39], v[232:235]
    s_waitcnt lgkmcnt(2)
    v_mfma_f32_16x16x32_bf16 v[236:239], v[68:71], v[36:39], v[236:239]
    ds_read_b128 v[32:35], v2 offset:4096
    v_mfma_f32_16x16x32_bf16 v[232:235], v[72:75], v[40:43], v[232:235]
    ds_read_b128 v[36:39], v3 offset:4096
    v_mfma_f32_16x16x32_bf16 v[236:239], v[76:79], v[40:43], v[236:239]
    v_mfma_f32_16x16x32_bf16 v[232:235], v[80:83], v[16:19], v[232:235]
    ds_read_b128 v[40:43], v2 offset:8192
    v_mfma_f32_16x16x32_bf16 v[236:239], v[84:87], v[16:19], v[236:239]
    v_mfma_f32_16x16x32_bf16 v[232:235], v[88:91], v[20:23], v[232:235]
    s_waitcnt lgkmcnt(2)
    v_mfma_f32_16x16x32_bf16 v[236:239], v[92:95], v[20:23], v[236:239]
    ds_read_b128 v[16:19], v3 offset:8192
    v_mfma_f32_16x16x32_bf16 v[240:243], v[112:115], v[24:27], v[240:243]
    ds_read_b128 v[20:23], v2 offset:12288
    v_mfma_f32_16x16x32_bf16 v[244:247], v[116:119], v[24:27], v[244:247]
    v_mfma_f32_16x16x32_bf16 v[240:243], v[120:123], v[28:31], v[240:243]
    ds_read_b128 v[24:27], v3 offset:12288
    v_cvt_pk_bf16_f32 v228, v232, v233
    v_mfma_f32_16x16x32_bf16 v[244:247], v[124:127], v[28:31], v[244:247]
    v_cvt_pk_bf16_f32 v229, v234, v235
    v_cvt_pk_bf16_f32 v230, v236, v237
    v_mfma_f32_16x16x32_bf16 v[240:243], v[48:51], v[32:35], v[240:243]
    s_waitcnt lgkmcnt(2)
    ds_read_b128 v[28:31], v2 offset:2048
    v_cvt_pk_bf16_f32 v231, v238, v239
    v_mfma_f32_16x16x32_bf16 v[244:247], v[52:55], v[32:35], v[244:247]
    s_xor_b32 s39, s38, 0x34000
    buffer_store_dwordx4 v[228:231], v44, s[20:23], s39 offen sc0 sc1 nt
    v_mfma_f32_16x16x32_bf16 v[240:243], v[56:59], v[36:39], v[240:243]
    ds_read_b128 v[32:35], v3 offset:2048
    v_mfma_f32_16x16x32_bf16 v[244:247], v[60:63], v[36:39], v[244:247]
    v_mfma_f32_16x16x32_bf16 v[240:243], v[64:67], v[40:43], v[240:243]
    ds_read_b128 v[36:39], v2 offset:6144
    v_mfma_f32_16x16x32_bf16 v[244:247], v[68:71], v[40:43], v[244:247]
    v_mfma_f32_16x16x32_bf16 v[240:243], v[72:75], v[16:19], v[240:243]
    s_waitcnt lgkmcnt(2)
    v_mfma_f32_16x16x32_bf16 v[244:247], v[76:79], v[16:19], v[244:247]
    ds_read_b128 v[40:43], v3 offset:6144
    v_mfma_f32_16x16x32_bf16 v[240:243], v[80:83], v[20:23], v[240:243]
    ds_read_b128 v[16:19], v2 offset:10240
    v_mfma_f32_16x16x32_bf16 v[244:247], v[84:87], v[20:23], v[244:247]
    v_mfma_f32_16x16x32_bf16 v[240:243], v[88:91], v[24:27], v[240:243]
    ds_read_b128 v[20:23], v3 offset:10240
    v_mfma_f32_16x16x32_bf16 v[244:247], v[92:95], v[24:27], v[244:247]
    v_mfma_f32_16x16x32_bf16 v[248:251], v[112:115], v[28:31], v[248:251]
    s_waitcnt lgkmcnt(2)
    v_mfma_f32_16x16x32_bf16 v[252:255], v[116:119], v[28:31], v[252:255]
    ds_read_b128 v[24:27], v2 offset:14336
    v_mfma_f32_16x16x32_bf16 v[248:251], v[120:123], v[32:35], v[248:251]
    ds_read_b128 v[28:31], v3 offset:14336
    v_cvt_pk_bf16_f32 v240, v240, v241
    v_mfma_f32_16x16x32_bf16 v[252:255], v[124:127], v[32:35], v[252:255]
    v_cvt_pk_bf16_f32 v241, v242, v243
    v_cvt_pk_bf16_f32 v242, v244, v245
    v_mfma_f32_16x16x32_bf16 v[248:251], v[48:51], v[36:39], v[248:251]
    v_cvt_pk_bf16_f32 v243, v246, v247
    s_xor_b32 s39, s38, 0x38000
    v_mfma_f32_16x16x32_bf16 v[252:255], v[52:55], v[36:39], v[252:255]
    buffer_store_dwordx4 v[240:243], v44, s[20:23], s39 offen sc0 sc1 nt
    v_mfma_f32_16x16x32_bf16 v[248:251], v[56:59], v[40:43], v[248:251]
    s_waitcnt lgkmcnt(1)
    v_mfma_f32_16x16x32_bf16 v[252:255], v[60:63], v[40:43], v[252:255]
    v_mfma_f32_16x16x32_bf16 v[248:251], v[64:67], v[16:19], v[248:251]
    v_mfma_f32_16x16x32_bf16 v[252:255], v[68:71], v[16:19], v[252:255]
    v_mfma_f32_16x16x32_bf16 v[248:251], v[72:75], v[20:23], v[248:251]
    v_mfma_f32_16x16x32_bf16 v[252:255], v[76:79], v[20:23], v[252:255]
    v_mfma_f32_16x16x32_bf16 v[248:251], v[80:83], v[24:27], v[248:251]
    s_waitcnt lgkmcnt(0)
    v_mfma_f32_16x16x32_bf16 v[252:255], v[84:87], v[24:27], v[252:255]
    v_mfma_f32_16x16x32_bf16 v[248:251], v[88:91], v[28:31], v[248:251]
    v_mfma_f32_16x16x32_bf16 v[252:255], v[92:95], v[28:31], v[252:255]
    s_nop 6
    v_cvt_pk_bf16_f32 v244, v248, v249
    v_cvt_pk_bf16_f32 v245, v250, v251
    v_cvt_pk_bf16_f32 v246, v252, v253
    v_cvt_pk_bf16_f32 v247, v254, v255
    s_xor_b32 s39, s38, 0x3c000
    buffer_store_dwordx4 v[244:247], v44, s[20:23], s39 offen sc0 sc1 nt
    s_endpgm
L_spin_C3:
    ds_read_b32 v11, v8 offset:120
    s_sub_u32 s33, s33, 1
    s_cbranch_scc1 L_end
    s_waitcnt lgkmcnt(0)
    v_cmp_ne_u32 vcc, 0, v11
    s_cbranch_vccnz L_spin_C3
    s_branch L_back_C3
L_spin_C4:
    ds_read_b32 v11, v8 offset:116
    s_sub_u32 s33, s33, 1
    s_cbranch_scc1 L_end
    s_waitcnt lgkmcnt(0)
    v_cmp_ne_u32 vcc, 0, v11
    s_cbranch_vccnz L_spin_C4
    s_branch L_back_C4
L_spin_C5:
    ds_read_b32 v11, v8 offset:112
    s_sub_u32 s33, s33, 1
    s_cbranch_scc1 L_end
    s_waitcnt lgkmcnt(0)
    v_cmp_ne_u32 vcc, 0, v11
    s_cbranch_vccnz L_spin_C5
    s_branch L_back_C5
L_spin_C6:
    ds_read_b32 v11, v8 offset:108
    s_sub_u32 s33, s33, 1
    s_cbranch_scc1 L_end
    s_waitcnt lgkmcnt(0)
    v_cmp_ne_u32 vcc, 0, v11
    s_cbranch_vccnz L_spin_C6
    s_branch L_back_C6
L_spin_C7:
    ds_read_b32 v11, v8 offset:104
    s_sub_u32 s33, s33, 1
    s_cbranch_scc1 L_end
    s_waitcnt lgkmcnt(0)
    v_cmp_ne_u32 vcc, 0, v11
    s_cbranch_vccnz L_spin_C7
    s_branch L_back_C7
L_spin_C8:
    ds_read_b32 v11, v8 offset:100
    s_sub_u32 s33, s33, 1
    s_cbranch_scc1 L_end
    s_waitcnt lgkmcnt(0)
    v_cmp_ne_u32 vcc, 0, v11
    s_cbranch_vccnz L_spin_C8
    s_branch L_back_C8
L_spin_C9:
    ds_read_b32 v11, v8 offset:96
    s_sub_u32 s33, s33, 1
    s_cbranch_scc1 L_end
    s_waitcnt lgkmcnt(0)
    v_cmp_ne_u32 vcc, 0, v11
    s_cbranch_vccnz L_spin_C9
    s_branch L_back_C9
L_spin_C10:
    ds_read_b32 v11, v8 offset:92
    s_sub_u32 s33, s33, 1
    s_cbranch_scc1 L_end
    s_waitcnt lgkmcnt(0)
    v_cmp_ne_u32 vcc, 0, v11
    s_cbranch_vccnz L_spin_C10
    s_branch L_back_C10
L_spin_C11:
    ds_read_b32 v11, v8 offset:88
    s_sub_u32 s33, s33, 1
    s_cbranch_scc1 L_end
    s_waitcnt lgkmcnt(0)
    v_cmp_ne_u32 vcc, 0, v11
    s_cbranch_vccnz L_spin_C11
    s_branch L_back_C11
L_spin_C12:
    ds_read_b32 v11, v8 offset:84
    s_sub_u32 s33, s33, 1
    s_cbranch_scc1 L_end
    s_waitcnt lgkmcnt(0)
    v_cmp_ne_u32 vcc, 0, v11
    s_cbranch_vccnz L_spin_C12
    s_branch L_back_C12
L_spin_C13:
    ds_read_b32 v11, v8 offset:80
    s_sub_u32 s33, s33, 1
    s_cbranch_scc1 L_end
    s_waitcnt lgkmcnt(0)
    v_cmp_ne_u32 vcc, 0, v11
    s_cbranch_vccnz L_spin_C13
    s_branch L_back_C13
L_spin_C14:
    ds_read_b32 v11, v8 offset:76
    s_sub_u32 s33, s33, 1
    s_cbranch_scc1 L_end
    s_waitcnt lgkmcnt(0)
    v_cmp_ne_u32 vcc, 0, v11
    s_cbranch_vccnz L_spin_C14
    s_branch L_back_C14
L_spin_C15:
    ds_read_b32 v11, v8 offset:72
    s_sub_u32 s33, s33, 1
    s_cbranch_scc1 L_end
    s_waitcnt lgkmcnt(0)
    v_cmp_ne_u32 vcc, 0, v11
    s_cbranch_vccnz L_spin_C15
    s_branch L_back_C15
L_spin_C16:
    ds_read_b32 v11, v8 offset:68
    s_sub_u32 s33, s33, 1
    s_cbranch_scc1 L_end
    s_waitcnt lgkmcnt(0)
    v_cmp_ne_u32 vcc, 0, v11
    s_cbranch_vccnz L_spin_C16
    s_branch L_back_C16
L_spin_C17:
    ds_read_b32 v11, v8 offset:64
    s_sub_u32 s33, s33, 1
    s_cbranch_scc1 L_end
    s_waitcnt lgkmcnt(0)
    v_cmp_ne_u32 vcc, 0, v11
    s_cbranch_vccnz L_spin_C17
    s_branch L_back_C17
L_spin_C18:
    ds_read_b32 v11, v8 offset:60
    s_sub_u32 s33, s33, 1
    s_cbranch_scc1 L_end
    s_waitcnt lgkmcnt(0)
    v_cmp_ne_u32 vcc, 0, v11
    s_cbranch_vccnz L_spin_C18
    s_branch L_back_C18
L_end:
    s_endpgm
.section .rodata,"a"
.p2align 6
.amdhsa_kernel standalone__structured_sparse_n_m__ragged_kernel
  .amdhsa_next_free_vgpr 256
  .amdhsa_next_free_sgpr 96
  .amdhsa_accum_offset 256
  .amdhsa_group_segment_fixed_size 0
  .amdhsa_kernarg_size 48
  .amdhsa_user_sgpr_count 2
  .amdhsa_user_sgpr_kernarg_segment_ptr 1
  .amdhsa_system_sgpr_workgroup_id_x 1
.end_amdhsa_kernel
```
